```python
import torch

def _softmax(x, axis=-1):
    return torch.softmax(x, dim=axis)
def _gelu(x):
    return torch.nn.functional.gelu(x, approximate="tanh")
def _silu(x):
    return torch.nn.functional.silu(x)
def _sigmoid(x):
    return torch.sigmoid(x)
def _layernorm(x, axis=-1, eps=1e-5):
    m = x.mean(dim=axis, keepdim=True)
    v = x.var(dim=axis, keepdim=True, unbiased=False)
    return (x - m) / torch.sqrt(v + eps)
def _scatter_add(tgt, idx, src, axis=0):
    return tgt.clone().index_add_(axis, idx, src)
def _segment_sum(src, seg, n):
    out = torch.zeros((n,) + src.shape[1:], dtype=src.dtype)
    return out.index_add_(0, seg, src)
def _pad(x, pw):
    flat = tuple(v for pair in reversed(pw) for v in pair)
    return torch.nn.functional.pad(x, flat)

kernel_name = 'recurrent_scan__spectral_fnet__moe_arch_mod__prompt'

def setup_inputs():

    _w = (lambda a: (lambda t: t.to(torch.bfloat16) if t.is_floating_point() else t)(torch.as_tensor(a)))
    def _A_setup():
        B, S, D = 1, 2048, 640
        ns = torch.arange(S)[:, None] * torch.arange(S)[None, :]
        nd = torch.arange(D)[:, None] * torch.arange(D)[None, :]
        Ws_re = torch.cos(-2.0 * torch.pi * ns / S).to(float)
        Ws_im = torch.sin(-2.0 * torch.pi * ns / S).to(float)
        Wd_re = torch.cos(-2.0 * torch.pi * nd / D).to(float)
        Wd_im = torch.sin(-2.0 * torch.pi * nd / D).to(float)
        return {
            "x": _w((lambda *s: torch.randn(*s, dtype=torch.bfloat16) * 0.1)(B, S, D)),
            "dft_seq_re": _w(Ws_re),
            "dft_seq_im": _w(Ws_im),
            "dft_hid_re": _w(Wd_re),
            "dft_hid_im": _w(Wd_im),
        }
    _A_in = _A_setup()

    def _B_setup():
        B, S, D, F, C = 1, 2048, 640, 1728, 2
        return {
            "x": _w((lambda *s: torch.randn(*s, dtype=torch.bfloat16) * 0.1)(B, S, D)),
            "w_r": _w((lambda *s: torch.randn(*s, dtype=torch.bfloat16) * 0.1)(D)),
            "w_gate": _w((lambda *s: torch.randn(*s, dtype=torch.bfloat16) * 0.1)(D, F)),
            "w_up": _w((lambda *s: torch.randn(*s, dtype=torch.bfloat16) * 0.1)(D, F)),
            "w_down": _w((lambda *s: torch.randn(*s, dtype=torch.bfloat16) * 0.1)(F, D)),
        }
    _B_in = _B_setup()

    return {
        "A_x": _A_in["x"],
        "A_dft_seq_re": _A_in["dft_seq_re"],
        "A_dft_seq_im": _A_in["dft_seq_im"],
        "A_dft_hid_re": _A_in["dft_hid_re"],
        "A_dft_hid_im": _A_in["dft_hid_im"],
        "B_x": _B_in["x"],
        "B_w_r": _B_in["w_r"],
        "B_w_gate": _B_in["w_gate"],
        "B_w_up": _B_in["w_up"],
        "B_w_down": _B_in["w_down"],
    }

def reference(A_x, A_dft_seq_re, A_dft_seq_im, A_dft_hid_re, A_dft_hid_im, B_x, B_w_r, B_w_gate, B_w_up, B_w_down):
    def _A_ref(x, dft_seq_re, dft_seq_im, dft_hid_re, dft_hid_im):
        a = torch.einsum("bsd,ed->bse", x, dft_hid_re)
        b = torch.einsum("bsd,ed->bse", x, dft_hid_im)
        y = torch.einsum("ts,bse->bte", dft_seq_re, a) - torch.einsum("ts,bse->bte", dft_seq_im, b)
        return y

    def _B_ref(x, w_r, w_gate, w_up, w_down):
        B, S, D = x.shape
        C = 2
        r = x @ w_r
        idx = torch.argsort(-r, axis=-1)[:, :C]
        idx_e = (lambda x, n, axis: torch.repeat_interleave(x, n, dim=axis))(idx.reshape(B, C, 1), D, axis=2)
        x_sel = (lambda x, i, axis: torch.take_along_dim(x, i, dim=axis))(x, idx_e, axis=1)
        g = _silu(x_sel @ w_gate)
        u = x_sel @ w_up
        y = (g * u) @ w_down
        r_sel = _sigmoid((lambda x, i, axis: torch.take_along_dim(x, i, dim=axis))(r, idx, axis=1))
        y = y * r_sel.reshape(B, C, 1)
        b_off = (torch.arange(B) * S).reshape(B, 1)
        flat_idx = (idx + b_off).reshape(B * C)
        zero = (x * 0.0).reshape(B * S, D)
        upd = _scatter_add(zero, flat_idx, y.reshape(B * C, D), axis=0)
        return x + upd.reshape(B, S, D)

    x = A_x
    xn = _layernorm(x, axis=-1)
    s = _A_ref(xn, A_dft_seq_re, A_dft_seq_im, A_dft_hid_re, A_dft_hid_im)
    g = _silu(_B_ref(xn, B_w_r, B_w_gate, B_w_up, B_w_down))
    return x + s * g
```

```asm
; @launch grid=(256,1,1) block=(768,1,1) lds=63072
.amdgcn_target "amdgcn-amd-amdhsa--gfx950"
.text
.globl recurrent_scan__spectral_fnet__moe_arch_mod__prompt_kernel
.p2align 8
.type recurrent_scan__spectral_fnet__moe_arch_mod__prompt_kernel,@function
recurrent_scan__spectral_fnet__moe_arch_mod__prompt_kernel:
    s_load_dwordx2 s[16:17], s[0:1], 0
    s_load_dwordx4 s[28:31], s[0:1], 48
    s_load_dwordx8 s[32:39], s[0:1], 64
    s_load_dwordx2 s[40:41], s[0:1], 96
    s_cmp_ge_u32 s2, 256
    s_cbranch_scc1 L_end
    s_getpc_b64 s[4:5]
L_pc:
    v_lshrrev_b32 v1, 6, v0
    s_bfe_u32 s64, s2, 0x20003
    s_mul_i32 s64, s64, 36
    v_and_b32 v2, 15, v0
    v_readfirstlane_b32 s45, v1
    v_mad_u32_u24 v4, v1, 3, s64
    v_add_lshl_u32 v4, v4, v2, 7
    s_mov_b64 exec, 7
    global_load_dword v127, v4, s[4:5]
    s_mov_b64 exec, -1
    v_bfe_u32 v3, v0, 4, 2
    s_and_b32 s64, s2, 7
    s_bfe_u32 s66, s2, 0x10005
    s_lshl1_add_u32 s64, s64, s66
    s_sub_u32 s66, 32, s64
    s_cmp_eq_u32 s64, 0
    s_cselect_b32 s66, 16, s66
    s_bitcmp1_b32 s2, 4
    s_cselect_b32 s47, s66, s64
    s_and_b32 s67, s2, 8
    s_lshl2_add_u32 s46, s67, s47
    s_lshr_b32 s50, s2, 7
    s_cmp_ge_u32 s45, 4
    s_cbranch_scc1 L_A_unit
    s_add_u32 s6, s4, L_tab-L_pc
    s_addc_u32 s7, s5, 0
    s_lshr_b32 s74, s2, 6
    s_mul_i32 s74, s74, 5120
    v_and_b32 v84, 63, v0
    v_lshl_add_u32 v84, v84, 4, s74
    global_load_dwordx4 v[48:51], v84, s[6:7] offset:-2048
    global_load_dwordx4 v[52:55], v84, s[6:7] offset:-1024
    global_load_dwordx4 v[56:59], v84, s[6:7]
    global_load_dwordx4 v[60:63], v84, s[6:7] offset:1024
    global_load_dwordx4 v[64:67], v84, s[6:7] offset:2048
    s_setprio 3
    v_lshl_add_u32 v4, v1, 3, v3
    v_lshl_add_u32 v5, v4, 6, s46
    v_mul_u32_u24 v5, 1280, v5
    s_mul_i32 s69, s50, 640
    s_sub_u32 s68, 640, s69
    v_add_u32 v6, s68, v5
    v_add_u32 v5, s69, v5
    v_lshlrev_b32 v72, 4, v2
    v_sub_u32 v73, 240, v72
    v_lshlrev_b32 v74, 2, v2
    v_sub_u32 v75, 60, v74
    v_add_u32 v76, v5, v72
    v_add_u32 v80, v6, v72
    v_add_u32 v81, v6, v73
    v_add_u32 v77, v5, v73
    v_add_u32 v78, v5, v74
    v_add_u32 v82, v6, v74
    v_add_u32 v83, v6, v75
    v_add_u32 v79, v5, v75
    s_waitcnt lgkmcnt(0)
    global_load_dwordx4 v[8:11], v76, s[16:17]
    global_load_dwordx4 v[12:15], v80, s[16:17]
    global_load_dwordx4 v[16:19], v81, s[16:17] offset:384
    global_load_dwordx4 v[20:23], v77, s[16:17] offset:384
    global_load_dword v24, v78, s[16:17] offset:256
    global_load_dword v25, v82, s[16:17] offset:256
    global_load_dword v26, v83, s[16:17] offset:320
    global_load_dword v27, v79, s[16:17] offset:320
    s_add_u32 s18, s16, 327680
    s_addc_u32 s19, s17, 0
    s_load_dword s44, s[40:41], 0
    s_cmp_ge_u32 s2, 64
    s_cbranch_scc1 L_now
    global_load_dwordx4 v[92:95], v72, s[28:29]
    global_load_dwordx4 v[96:99], v72, s[28:29] offset:640
    global_load_dwordx4 v[100:103], v73, s[28:29] offset:1024
    global_load_dwordx4 v[104:107], v73, s[28:29] offset:384
    global_load_dword v108, v74, s[28:29] offset:256
    global_load_dword v109, v74, s[28:29] offset:896
    global_load_dword v110, v75, s[28:29] offset:960
    global_load_dword v111, v75, s[28:29] offset:320
L_now:
    global_load_dwordx4 v[28:31], v76, s[18:19]
    global_load_dwordx4 v[32:35], v80, s[18:19]
    global_load_dwordx4 v[36:39], v81, s[18:19] offset:384
    global_load_dwordx4 v[40:43], v77, s[18:19] offset:384
    global_load_dword v44, v78, s[18:19] offset:256
    global_load_dword v45, v82, s[18:19] offset:256
    global_load_dword v46, v83, s[18:19] offset:320
    global_load_dword v47, v79, s[18:19] offset:320
    v_and_b32 v1, 63, v0
    s_mov_b32 s57, 0xffff0000
    s_mov_b32 s55, 0x3f803f80
    s_mov_b32 s62, 16777216
    s_mov_b32 s63, 0x20000
    s_mov_b32 s58, 2000000
    s_lshr_b32 s48, s2, 6
    s_and_b32 s49, s48, 1
    s_mul_i32 s56, s48, 80
    v_mul_u32_u24 v5, 656, v4
    v_add_u32 v6, v5, v72
    v_add_u32 v7, v5, v74
    v_add_u32 v68, v5, v73
    v_add_u32 v69, v5, v75
    v_lshrrev_b32 v5, 3, v2
    v_lshl_add_u32 v4, v5, 2, v4
    v_lshlrev_b32 v5, 3, v4
    v_lshl_add_u32 v4, v4, 6, s46
    v_sub_u32 v4, 2047, v4
    v_mul_u32_u24 v70, 4352, v1
    s_lshl2_add_u32 s26, s46, s45
    s_lshl_b32 s26, s26, 4
    s_add_u32 s26, s26, 8192
    s_cmp_eq_u32 s49, 0
    s_cselect_b32 s52, 1.0, -1.0
    s_cselect_b32 s53, 2.0, 0
    s_mov_b32 s70, 0x00010001
    s_mov_b32 s71, 0x00010001
    s_mov_b32 s75, 0xfffff800
    v_mov_b32 v71, 0
    v_mov_b32 v112, 0
    v_mov_b32 v114, 0
    v_mov_b32 v115, 0
    v_mov_b32 v116, 0
    v_mov_b32 v118, 0
    v_mov_b32 v119, 0
    s_mov_b32 s60, s40
    s_mov_b32 s61, s41
    s_waitcnt lgkmcnt(0)
    s_add_u32 s44, s44, 2654435769
    s_cmp_lg_u32 s48, 0
    s_cbranch_scc1 L_np
    s_waitcnt vmcnt(23)
    v_dot2c_f32_bf16 v112, s55, v8
    v_dot2c_f32_bf16 v114, v8, v8
    ds_write_b128 v6, v[8:11] offset:37376
    v_dot2c_f32_bf16 v112, s55, v9
    v_dot2c_f32_bf16 v114, v9, v9
    v_dot2c_f32_bf16 v112, s55, v10
    v_dot2c_f32_bf16 v114, v10, v10
    v_dot2c_f32_bf16 v112, s55, v11
    v_dot2c_f32_bf16 v114, v11, v11
    s_waitcnt vmcnt(22)
    v_dot2c_f32_bf16 v112, s55, v12
    v_dot2c_f32_bf16 v114, v12, v12
    v_dot2c_f32_bf16 v112, s55, v13
    v_dot2c_f32_bf16 v114, v13, v13
    v_dot2c_f32_bf16 v112, s55, v14
    v_dot2c_f32_bf16 v114, v14, v14
    v_dot2c_f32_bf16 v112, s55, v15
    v_dot2c_f32_bf16 v114, v15, v15
    s_waitcnt vmcnt(21)
    v_dot2c_f32_bf16 v112, s55, v16
    v_dot2c_f32_bf16 v114, v16, v16
    ds_write_b128 v68, v[16:19] offset:37760
    v_dot2c_f32_bf16 v112, s55, v17
    v_dot2c_f32_bf16 v114, v17, v17
    v_dot2c_f32_bf16 v112, s55, v18
    v_dot2c_f32_bf16 v114, v18, v18
    v_dot2c_f32_bf16 v112, s55, v19
    v_dot2c_f32_bf16 v114, v19, v19
    s_waitcnt vmcnt(20)
    v_dot2c_f32_bf16 v112, s55, v20
    v_dot2c_f32_bf16 v114, v20, v20
    v_dot2c_f32_bf16 v112, s55, v21
    v_dot2c_f32_bf16 v114, v21, v21
    v_dot2c_f32_bf16 v112, s55, v22
    v_dot2c_f32_bf16 v114, v22, v22
    v_dot2c_f32_bf16 v112, s55, v23
    v_dot2c_f32_bf16 v114, v23, v23
    s_waitcnt vmcnt(16)
    v_dot2c_f32_bf16 v112, s55, v24
    v_dot2c_f32_bf16 v114, v24, v24
    ds_write_b32 v7, v24 offset:37632
    v_dot2c_f32_bf16 v112, s55, v25
    v_dot2c_f32_bf16 v114, v25, v25
    ds_write_b32 v69, v26 offset:37696
    v_dot2c_f32_bf16 v112, s55, v26
    v_dot2c_f32_bf16 v114, v26, v26
    v_dot2c_f32_bf16 v112, s55, v27
    v_dot2c_f32_bf16 v114, v27, v27
    s_waitcnt vmcnt(8)
    v_dot2c_f32_bf16 v71, s55, v92
    v_dot2c_f32_bf16 v115, v92, v8
    v_dot2c_f32_bf16 v71, s55, v93
    v_dot2c_f32_bf16 v115, v93, v9
    v_dot2c_f32_bf16 v71, s55, v94
    v_dot2c_f32_bf16 v115, v94, v10
    v_dot2c_f32_bf16 v71, s55, v95
    v_dot2c_f32_bf16 v115, v95, v11
    v_dot2c_f32_bf16 v71, s55, v96
    v_dot2c_f32_bf16 v115, v96, v12
    v_dot2c_f32_bf16 v71, s55, v97
    v_dot2c_f32_bf16 v115, v97, v13
    v_dot2c_f32_bf16 v71, s55, v98
    v_dot2c_f32_bf16 v115, v98, v14
    v_dot2c_f32_bf16 v71, s55, v99
    v_dot2c_f32_bf16 v115, v99, v15
    v_dot2c_f32_bf16 v71, s55, v100
    v_dot2c_f32_bf16 v115, v100, v16
    v_dot2c_f32_bf16 v71, s55, v101
    v_dot2c_f32_bf16 v115, v101, v17
    v_dot2c_f32_bf16 v71, s55, v102
    v_dot2c_f32_bf16 v115, v102, v18
    v_dot2c_f32_bf16 v71, s55, v103
    v_dot2c_f32_bf16 v115, v103, v19
    v_dot2c_f32_bf16 v71, s55, v104
    v_dot2c_f32_bf16 v115, v104, v20
    v_dot2c_f32_bf16 v71, s55, v105
    v_dot2c_f32_bf16 v115, v105, v21
    v_dot2c_f32_bf16 v71, s55, v106
    v_dot2c_f32_bf16 v115, v106, v22
    v_dot2c_f32_bf16 v71, s55, v107
    v_dot2c_f32_bf16 v115, v107, v23
    v_dot2c_f32_bf16 v71, s55, v108
    v_dot2c_f32_bf16 v115, v108, v24
    v_dot2c_f32_bf16 v71, s55, v109
    v_dot2c_f32_bf16 v115, v109, v25
    v_dot2c_f32_bf16 v71, s55, v110
    v_dot2c_f32_bf16 v115, v110, v26
    v_dot2c_f32_bf16 v71, s55, v111
    v_dot2c_f32_bf16 v115, v111, v27
    s_waitcnt vmcnt(7)
    v_dot2c_f32_bf16 v116, s55, v28
    v_dot2c_f32_bf16 v118, v28, v28
    v_dot2c_f32_bf16 v119, v92, v28
    ds_write_b128 v6, v[28:31] offset:40000
    v_dot2c_f32_bf16 v116, s55, v29
    v_dot2c_f32_bf16 v118, v29, v29
    v_dot2c_f32_bf16 v119, v93, v29
    v_dot2c_f32_bf16 v116, s55, v30
    v_dot2c_f32_bf16 v118, v30, v30
    v_dot2c_f32_bf16 v119, v94, v30
    v_dot2c_f32_bf16 v116, s55, v31
    v_dot2c_f32_bf16 v118, v31, v31
    v_dot2c_f32_bf16 v119, v95, v31
    s_waitcnt vmcnt(6)
    v_dot2c_f32_bf16 v116, s55, v32
    v_dot2c_f32_bf16 v118, v32, v32
    v_dot2c_f32_bf16 v119, v96, v32
    v_dot2c_f32_bf16 v116, s55, v33
    v_dot2c_f32_bf16 v118, v33, v33
    v_dot2c_f32_bf16 v119, v97, v33
    v_dot2c_f32_bf16 v116, s55, v34
    v_dot2c_f32_bf16 v118, v34, v34
    v_dot2c_f32_bf16 v119, v98, v34
    v_dot2c_f32_bf16 v116, s55, v35
    v_dot2c_f32_bf16 v118, v35, v35
    v_dot2c_f32_bf16 v119, v99, v35
    s_waitcnt vmcnt(5)
    v_dot2c_f32_bf16 v116, s55, v36
    v_dot2c_f32_bf16 v118, v36, v36
    v_dot2c_f32_bf16 v119, v100, v36
    ds_write_b128 v68, v[36:39] offset:40384
    v_dot2c_f32_bf16 v116, s55, v37
    v_dot2c_f32_bf16 v118, v37, v37
    v_dot2c_f32_bf16 v119, v101, v37
    v_dot2c_f32_bf16 v116, s55, v38
    v_dot2c_f32_bf16 v118, v38, v38
    v_dot2c_f32_bf16 v119, v102, v38
    v_dot2c_f32_bf16 v116, s55, v39
    v_dot2c_f32_bf16 v118, v39, v39
    v_dot2c_f32_bf16 v119, v103, v39
    s_waitcnt vmcnt(4)
    v_dot2c_f32_bf16 v116, s55, v40
    v_dot2c_f32_bf16 v118, v40, v40
    v_dot2c_f32_bf16 v119, v104, v40
    v_dot2c_f32_bf16 v116, s55, v41
    v_dot2c_f32_bf16 v118, v41, v41
    v_dot2c_f32_bf16 v119, v105, v41
    v_dot2c_f32_bf16 v116, s55, v42
    v_dot2c_f32_bf16 v118, v42, v42
    v_dot2c_f32_bf16 v119, v106, v42
    v_dot2c_f32_bf16 v116, s55, v43
    v_dot2c_f32_bf16 v118, v43, v43
    v_dot2c_f32_bf16 v119, v107, v43
    s_waitcnt vmcnt(0)
    v_dot2c_f32_bf16 v116, s55, v44
    v_dot2c_f32_bf16 v118, v44, v44
    v_dot2c_f32_bf16 v119, v108, v44
    ds_write_b32 v7, v44 offset:40256
    v_dot2c_f32_bf16 v116, s55, v45
    v_dot2c_f32_bf16 v118, v45, v45
    v_dot2c_f32_bf16 v119, v109, v45
    ds_write_b32 v69, v46 offset:40320
    v_dot2c_f32_bf16 v116, s55, v46
    v_dot2c_f32_bf16 v118, v46, v46
    v_dot2c_f32_bf16 v119, v110, v46
    v_dot2c_f32_bf16 v116, s55, v47
    v_dot2c_f32_bf16 v118, v47, v47
    v_dot2c_f32_bf16 v119, v111, v47
    s_waitcnt vmcnt(0)
    v_mfma_f32_32x32x16_bf16 v[72:87], v[48:51], v[8:11], 0
    v_add_f32_dpp v112, v112, v112 row_ror:8 row_mask:0xf bank_mask:0xf
    v_add_f32_dpp v114, v114, v114 row_ror:8 row_mask:0xf bank_mask:0xf
    v_add_f32_dpp v115, v115, v115 row_ror:8 row_mask:0xf bank_mask:0xf
    v_add_f32_dpp v71, v71, v71 row_ror:8 row_mask:0xf bank_mask:0xf
    v_add_f32_dpp v112, v116, v116 row_ror:8 row_mask:0xf bank_mask:0xc
    v_add_f32_dpp v114, v118, v118 row_ror:8 row_mask:0xf bank_mask:0xc
    v_mfma_f32_32x32x16_bf16 v[72:87], v[52:55], v[12:15], v[72:87]
    v_add_f32_dpp v115, v119, v119 row_ror:8 row_mask:0xf bank_mask:0xc
    v_add_f32_dpp v112, v112, v112 row_half_mirror row_mask:0xf bank_mask:0xf
    v_add_f32_dpp v114, v114, v114 row_half_mirror row_mask:0xf bank_mask:0xf
    v_add_f32_dpp v115, v115, v115 row_half_mirror row_mask:0xf bank_mask:0xf
    v_add_f32_dpp v71, v71, v71 row_half_mirror row_mask:0xf bank_mask:0xf
    v_add_f32_dpp v112, v112, v112 quad_perm:[2,3,0,1] row_mask:0xf bank_mask:0xf
    v_mfma_f32_32x32x16_bf16 v[72:87], v[56:59], v[16:19], v[72:87]
    v_add_f32_dpp v114, v114, v114 quad_perm:[2,3,0,1] row_mask:0xf bank_mask:0xf
    v_add_f32_dpp v115, v115, v115 quad_perm:[2,3,0,1] row_mask:0xf bank_mask:0xf
    v_add_f32_dpp v71, v71, v71 quad_perm:[2,3,0,1] row_mask:0xf bank_mask:0xf
    v_add_f32_dpp v112, v112, v112 quad_perm:[1,0,3,2] row_mask:0xf bank_mask:0xf
    v_add_f32_dpp v114, v114, v114 quad_perm:[1,0,3,2] row_mask:0xf bank_mask:0xf
    v_add_f32_dpp v115, v115, v115 quad_perm:[1,0,3,2] row_mask:0xf bank_mask:0xf
    v_mfma_f32_32x32x16_bf16 v[72:87], v[60:63], v[20:23], v[72:87]
    v_add_f32_dpp v71, v71, v71 quad_perm:[1,0,3,2] row_mask:0xf bank_mask:0xf
    v_mul_f32 v112, 0x3acccccd, v112
    v_mul_f32 v114, 0x3acccccd, v114
    v_cvt_pk_bf16_f32 v113, v112, v112
    v_fma_f32 v114, -v112, v112, v114
    v_lshlrev_b32 v112, 16, v113
    v_mfma_f32_16x16x32_bf16 v[88:91], v[64:67], v[24:27], 0
    v_max_f32 v114, 0, v114
    v_cvt_pk_bf16_f32 v114, v114, v114
    v_lshlrev_b32 v114, 16, v114
    v_add_f32 v114, 0x3727c5ac, v114
    v_cvt_pk_bf16_f32 v114, v114, v114
    v_lshlrev_b32 v114, 16, v114
    v_mfma_f32_32x32x16_bf16 v[92:107], v[48:51], v[28:31], 0
    v_sqrt_f32 v114, v114
    v_fma_f32 v115, -v112, v71, v115
    v_cvt_pk_bf16_f32 v114, v114, v114
    v_lshlrev_b32 v114, 16, v114
    v_rcp_f32 v113, v114
    v_mov_b32 v127, s44
    v_mfma_f32_32x32x16_bf16 v[92:107], v[52:55], v[32:35], v[92:107]
    v_mul_f32 v115, v115, v113
    v_ashrrev_i32 v114, 31, v115
    v_or_b32 v114, 0x80000000, v114
    v_xor_b32 v115, v115, v114
    v_and_or_b32 v115, v115, s75, v4
    s_waitcnt vmcnt(0)
    v_mfma_f32_32x32x16_bf16 v[92:107], v[56:59], v[36:39], v[92:107]
    v_max_u32_dpp v124, v115, v115 row_ror:8 row_mask:0xf bank_mask:0xf
    v_min_u32_dpp v125, v115, v115 row_ror:8 row_mask:0xf bank_mask:0xf
    v_mov_b32 v120, v124
    v_mov_b32 v121, v125
    s_nop 0
    v_permlane32_swap_b32 v120, v124
    v_permlane32_swap_b32 v121, v125
    v_mfma_f32_32x32x16_bf16 v[92:107], v[60:63], v[40:43], v[92:107]
    v_min_u32 v126, v120, v124
    v_max_u32 v124, v120, v124
    v_max3_u32 v125, v125, v121, v126
    v_mov_b32 v120, v124
    v_mov_b32 v121, v125
    s_nop 0
    v_permlane16_swap_b32 v120, v124
    v_mfma_f32_16x16x32_bf16 v[108:111], v[64:67], v[44:47], 0
    v_permlane16_swap_b32 v121, v125
    v_min_u32 v126, v120, v124
    v_max_u32 v124, v120, v124
    v_max3_u32 v125, v125, v121, v126
    s_mov_b64 exec, 0xffff
    buffer_store_dwordx4 v[124:127], v70, s[60:63], s26 offen sc1
    s_mov_b64 exec, -1
L_lnj:
    ds_write_b64 v5, v[112:113] offset:58368
    v_mov_b32 v116, v112
    v_mov_b32 v117, v113
    s_nop 0
    v_mov_b32_dpp v116, v112 row_ror:8 row_mask:0xf bank_mask:0x3
    v_mov_b32_dpp v117, v113 row_ror:8 row_mask:0xf bank_mask:0x3
    v_mov_b32_dpp v112, v112 row_ror:8 row_mask:0xf bank_mask:0xc
    v_mov_b32_dpp v113, v113 row_ror:8 row_mask:0xf bank_mask:0xc
    v_mul_f32 v121, s53, v116
    v_mul_f32 v120, s53, v112
    v_mul_f32 v124, -2.0, v121
    v_mov_b32 v116, v117
    v_mul_f32 v122, -2.0, v120
    v_mov_b32 v112, v113
    v_mov_b32_dpp v18, v80 row_ror:1 row_mask:0xf bank_mask:0xf
    v_mul_f32 v123, v122, v113
    v_mul_f32 v122, v122, v113
    v_mov_b32_dpp v19, v90 row_ror:1 row_mask:0xf bank_mask:0xf
    v_fma_f32 v20, s52, v19, -v120
    v_cndmask_b32 v19, v19, v18, s[70:71]
    v_cndmask_b32 v18, v18, v120, s[70:71]
    v_sub_f32 v90, v88, v19
    v_add_f32 v88, v88, v19
    v_sub_f32 v80, v72, v18
    v_add_f32 v72, v72, v18
    v_cndmask_b32 v80, v80, v20, s[70:71]
    v_pk_fma_f32 v[74:75], v[74:75], v[112:113], v[122:123]
    v_pk_fma_f32 v[76:77], v[76:77], v[112:113], v[122:123]
    v_pk_fma_f32 v[78:79], v[78:79], v[112:113], v[122:123]
    v_pk_fma_f32 v[72:73], v[72:73], v[112:113], v[122:123]
    v_pk_fma_f32 v[88:89], v[88:89], v[112:113], v[122:123]
    v_cvt_pk_bf16_f32 v9, v74, v75
    v_cvt_pk_bf16_f32 v10, v76, v77
    v_cvt_pk_bf16_f32 v11, v78, v79
    v_cvt_pk_bf16_f32 v8, v72, v73
    ds_write_b128 v6, v[8:11] offset:0
    v_cvt_pk_bf16_f32 v16, v88, v89
    v_pk_mul_f32 v[82:83], v[82:83], v[112:113]
    ds_write_b32 v7, v16 offset:256
    v_pk_mul_f32 v[84:85], v[84:85], v[112:113]
    v_pk_mul_f32 v[86:87], v[86:87], v[112:113]
    v_pk_mul_f32 v[80:81], v[80:81], v[112:113]
    v_pk_mul_f32 v[90:91], v[90:91], v[112:113]
    v_cvt_pk_bf16_f32 v13, v82, v83
    v_cvt_pk_bf16_f32 v14, v84, v85
    v_cvt_pk_bf16_f32 v15, v86, v87
    v_cvt_pk_bf16_f32 v12, v80, v81
    ds_write_b128 v6, v[12:15] offset:320
    v_cvt_pk_bf16_f32 v17, v90, v91
    ds_write_b32 v7, v17 offset:576
    v_mov_b32_dpp v38, v100 row_ror:1 row_mask:0xf bank_mask:0xf
    v_mul_f32 v125, v124, v117
    v_mul_f32 v124, v124, v117
    v_mov_b32_dpp v39, v110 row_ror:1 row_mask:0xf bank_mask:0xf
    v_fma_f32 v40, s52, v39, -v121
    v_cndmask_b32 v39, v39, v38, s[70:71]
    v_cndmask_b32 v38, v38, v121, s[70:71]
    v_sub_f32 v110, v108, v39
    v_add_f32 v108, v108, v39
    v_sub_f32 v100, v92, v38
    v_add_f32 v92, v92, v38
    v_cndmask_b32 v100, v100, v40, s[70:71]
    v_pk_fma_f32 v[94:95], v[94:95], v[116:117], v[124:125]
    v_pk_fma_f32 v[96:97], v[96:97], v[116:117], v[124:125]
    v_pk_fma_f32 v[98:99], v[98:99], v[116:117], v[124:125]
    v_pk_fma_f32 v[92:93], v[92:93], v[116:117], v[124:125]
    v_pk_fma_f32 v[108:109], v[108:109], v[116:117], v[124:125]
    v_cvt_pk_bf16_f32 v29, v94, v95
    v_cvt_pk_bf16_f32 v30, v96, v97
    v_cvt_pk_bf16_f32 v31, v98, v99
    v_cvt_pk_bf16_f32 v28, v92, v93
    ds_write_b128 v6, v[28:31] offset:2624
    v_cvt_pk_bf16_f32 v36, v108, v109
    v_pk_mul_f32 v[102:103], v[102:103], v[116:117]
    ds_write_b32 v7, v36 offset:2880
    v_pk_mul_f32 v[104:105], v[104:105], v[116:117]
    v_pk_mul_f32 v[106:107], v[106:107], v[116:117]
    v_pk_mul_f32 v[100:101], v[100:101], v[116:117]
    v_pk_mul_f32 v[110:111], v[110:111], v[116:117]
    v_cvt_pk_bf16_f32 v33, v102, v103
    v_cvt_pk_bf16_f32 v34, v104, v105
    v_cvt_pk_bf16_f32 v35, v106, v107
    v_cvt_pk_bf16_f32 v32, v100, v101
    ds_write_b128 v6, v[32:35] offset:2944
    v_cvt_pk_bf16_f32 v37, v110, v111
    ds_write_b32 v7, v37 offset:3200
    s_waitcnt lgkmcnt(0)
    s_barrier
    s_setprio 0
    s_mov_b32 s68, s45
L_P2:
    v_and_b32 v2, 31, v1
    v_lshrrev_b32 v3, 5, v1
    s_lshl_b32 s74, s49, 4
    s_add_u32 s74, s74, s56
    s_and_b32 s75, s68, 1
    s_lshl_b32 s75, s75, 5
    s_add_u32 s74, s74, s75
    s_sub_u32 s75, 608, s74
    s_cmp_ge_u32 s68, 2
    s_cselect_b32 s74, s75, s74
    s_add_u32 s75, s74, 16
    s_lshl_b32 s76, s49, 6
    s_sub_u32 s73, s56, s76
    s_add_u32 s73, s73, 64
    s_sub_u32 s76, 624, s73
    s_cmp_eq_u32 s68, 4
    s_cselect_b32 s20, s73, s74
    s_cselect_b32 s21, s76, s75
    v_mov_b32 v92, s20
    v_mov_b32 v93, s21
    s_mov_b32 s76, 0
    s_mov_b32 s77, -1
    v_cndmask_b32 v94, v92, v93, s[76:77]
    v_subrev_u32 v5, 320, v94
    v_min_u32 v5, v5, v94
    v_mul_u32_u24 v4, 656, v2
    v_lshl_add_u32 v4, v5, 1, v4
    v_lshlrev_b32 v6, 3, v2
    v_lshlrev_b32 v5, 4, v1
    v_add_u32 v6, 58368, v6
    ds_read2_b32 v[28:29], v6 offset0:1 offset1:1
    ds_read2_b32 v[6:7], v6 offset0:0 offset1:0
    ds_read_b128 v[24:27], v4 offset:37376
    ds_read_b128 v[124:127], v4 offset:37392
    s_cmp_lg_u32 s68, 4
    s_cbranch_scc1 L_P2b
    ds_read_b128 v[60:63], v5 offset:29184
    ds_read_b128 v[64:67], v5 offset:30208
    ds_read_b128 v[68:71], v5 offset:31232
    ds_read_b128 v[72:75], v5 offset:32256
    ds_read_b128 v[76:79], v5 offset:33280
    ds_read_b128 v[80:83], v5 offset:34304
    ds_read_b128 v[84:87], v5 offset:35328
    ds_read_b128 v[88:91], v5 offset:36352
    v_mov_b32 v30, 0
    s_waitcnt lgkmcnt(0)
    v_mov_b32 v31, 1
    s_mov_b64 exec, 1
    ds_add_u32 v30, v31 offset:60204
    s_mov_b64 exec, -1
    s_setprio 1
L_P2b:
    v_and_b32 v4, 15, v1
    v_lshlrev_b32 v4, 6, v4
    v_add_u32 v4, s46, v4
    v_mul_u32_u24 v0, 1280, v4
    v_lshl_add_u32 v0, v94, 1, v0
    v_and_b32 v94, 16, v1
    v_add_u32 v0, v0, v94
    s_mov_b32 s76, 0xf0f0f0f0
    s_mov_b32 s77, 0xf0f0f0f0
    v_cndmask_b32 v92, v92, v93, s[76:77]
    v_lshrrev_b32 v93, 3, v2
    v_lshl_add_u32 v92, v93, 2, v92
    v_and_b32 v93, 3, v2
    v_add_u32 v92, v92, v93
    s_sub_u32 s54, 32, s47
    s_min_u32 s54, s54, s47
    s_and_b32 s54, s54, 15
    s_cmp_ge_u32 s47, 16
    s_cselect_b32 s77, 16, 0
    s_xor_b32 s78, s77, 16
    s_cmp_eq_u32 s54, 0
    s_cselect_b32 s78, s77, s78
    v_sub_u32 v93, 640, v92
    v_cmp_le_u32 vcc, 320, v92
    s_nop 1
    v_cndmask_b32 v93, v92, v93, vcc
    v_and_b32 v2, 1, v93
    v_lshlrev_b32 v2, 6, v2
    v_subrev_u32 v94, s56, v93
    v_lshrrev_b32 v94, 1, v94
    v_mul_u32_u24 v93, 0x5556, v94
    v_lshrrev_b32 v93, 16, v93
    v_mad_i32_i24 v94, v93, -3, v94
    v_and_b32 v92, 1, v93
    v_lshl_add_u32 v2, v92, 5, v2
    v_lshrrev_b32 v93, 1, v93
    v_lshl_add_u32 v2, v94, 2, v2
    v_mov_b32 v92, s77
    v_mov_b32 v94, s78
    v_cndmask_b32 v92, v92, v94, vcc
    v_add_u32 v2, v2, v92
    v_lshl_add_u32 v2, v3, 9, v2
    v_mov_b32 v92, 0x80000000
    v_cndmask_b32 v3, 0, v92, vcc
    s_movk_i32 s79, 8208
    v_mad_u32_u24 v2, v93, s79, v2
    s_mov_b32 s70, 0xbfb8aa3b
    s_mov_b32 s71, 0xbfb8aa3b
    s_mov_b32 s74, 1.0
    s_mov_b32 s75, 1.0
    s_waitcnt lgkmcnt(0)
    v_mov_b32 v30, 0
L_ge:
    ds_read_b32 v31, v30 offset:60236
    s_waitcnt lgkmcnt(0)
    v_readfirstlane_b32 s73, v31
    s_nop 0
    s_cmp_ge_u32 s73, 1
    s_cbranch_scc1 L_ge_ok
    s_sleep 2
    s_sub_u32 s58, s58, 1
    s_cmp_lg_u32 s58, 0
    s_cbranch_scc1 L_ge
L_ge_ok:
    s_mov_b32 s58, 2000000
    v_lshlrev_b32 v8, 16, v24
    v_lshlrev_b32 v10, 16, v25
    v_lshlrev_b32 v12, 16, v26
    v_lshlrev_b32 v14, 16, v27
    v_lshlrev_b32 v16, 16, v124
    v_lshlrev_b32 v18, 16, v125
    v_lshlrev_b32 v20, 16, v126
    v_lshlrev_b32 v22, 16, v127
    v_and_b32 v9, s57, v24
    v_and_b32 v11, s57, v25
    v_and_b32 v13, s57, v26
    v_and_b32 v15, s57, v27
    v_and_b32 v17, s57, v124
    v_and_b32 v19, s57, v125
    v_and_b32 v21, s57, v126
    v_and_b32 v23, s57, v127
    v_pk_add_f32 v[108:109], v[8:9], v[6:7] neg_lo:[0,1] neg_hi:[0,1]
    v_pk_add_f32 v[110:111], v[10:11], v[6:7] neg_lo:[0,1] neg_hi:[0,1]
    v_pk_add_f32 v[112:113], v[12:13], v[6:7] neg_lo:[0,1] neg_hi:[0,1]
    v_pk_add_f32 v[114:115], v[14:15], v[6:7] neg_lo:[0,1] neg_hi:[0,1]
    v_pk_add_f32 v[116:117], v[16:17], v[6:7] neg_lo:[0,1] neg_hi:[0,1]
    v_pk_add_f32 v[118:119], v[18:19], v[6:7] neg_lo:[0,1] neg_hi:[0,1]
    v_pk_add_f32 v[120:121], v[20:21], v[6:7] neg_lo:[0,1] neg_hi:[0,1]
    v_pk_add_f32 v[122:123], v[22:23], v[6:7] neg_lo:[0,1] neg_hi:[0,1]
    v_cvt_pk_bf16_f32 v92, v108, v109
    v_cvt_pk_bf16_f32 v94, v110, v111
    v_cvt_pk_bf16_f32 v96, v112, v113
    v_cvt_pk_bf16_f32 v98, v114, v115
    v_cvt_pk_bf16_f32 v100, v116, v117
    v_cvt_pk_bf16_f32 v102, v118, v119
    v_cvt_pk_bf16_f32 v104, v120, v121
    v_cvt_pk_bf16_f32 v106, v122, v123
    v_lshlrev_b32 v108, 16, v92
    v_lshlrev_b32 v110, 16, v94
    v_lshlrev_b32 v112, 16, v96
    v_lshlrev_b32 v114, 16, v98
    v_lshlrev_b32 v116, 16, v100
    v_lshlrev_b32 v118, 16, v102
    v_lshlrev_b32 v120, 16, v104
    v_lshlrev_b32 v122, 16, v106
    v_and_b32 v109, s57, v92
    v_and_b32 v111, s57, v94
    v_and_b32 v113, s57, v96
    v_and_b32 v115, s57, v98
    v_and_b32 v117, s57, v100
    v_and_b32 v119, s57, v102
    v_and_b32 v121, s57, v104
    v_and_b32 v123, s57, v106
    v_pk_mul_f32 v[108:109], v[108:109], v[28:29]
    v_pk_mul_f32 v[110:111], v[110:111], v[28:29]
    v_pk_mul_f32 v[112:113], v[112:113], v[28:29]
    v_pk_mul_f32 v[114:115], v[114:115], v[28:29]
    v_pk_mul_f32 v[116:117], v[116:117], v[28:29]
    v_pk_mul_f32 v[118:119], v[118:119], v[28:29]
    v_pk_mul_f32 v[120:121], v[120:121], v[28:29]
    v_pk_mul_f32 v[122:123], v[122:123], v[28:29]
    v_cvt_pk_bf16_f32 v92, v108, v109
    v_cvt_pk_bf16_f32 v94, v110, v111
    v_cvt_pk_bf16_f32 v96, v112, v113
    v_cvt_pk_bf16_f32 v98, v114, v115
    v_cvt_pk_bf16_f32 v100, v116, v117
    v_cvt_pk_bf16_f32 v102, v118, v119
    v_cvt_pk_bf16_f32 v104, v120, v121
    v_cvt_pk_bf16_f32 v106, v122, v123
    v_lshlrev_b32 v108, 16, v92
    v_lshlrev_b32 v110, 16, v94
    v_lshlrev_b32 v112, 16, v96
    v_lshlrev_b32 v114, 16, v98
    v_lshlrev_b32 v116, 16, v100
    v_lshlrev_b32 v118, 16, v102
    v_lshlrev_b32 v120, 16, v104
    v_lshlrev_b32 v122, 16, v106
    v_and_b32 v109, s57, v92
    v_and_b32 v111, s57, v94
    v_and_b32 v113, s57, v96
    v_and_b32 v115, s57, v98
    v_and_b32 v117, s57, v100
    v_and_b32 v119, s57, v102
    v_and_b32 v121, s57, v104
    v_and_b32 v123, s57, v106
    v_pk_mul_f32 v[92:93], v[108:109], s[70:71]
    v_pk_mul_f32 v[94:95], v[110:111], s[70:71]
    v_pk_mul_f32 v[96:97], v[112:113], s[70:71]
    v_pk_mul_f32 v[98:99], v[114:115], s[70:71]
    v_pk_mul_f32 v[100:101], v[116:117], s[70:71]
    v_pk_mul_f32 v[102:103], v[118:119], s[70:71]
    v_pk_mul_f32 v[104:105], v[120:121], s[70:71]
    v_pk_mul_f32 v[106:107], v[122:123], s[70:71]
    v_exp_f32 v92, v92
    v_exp_f32 v94, v94
    v_exp_f32 v96, v96
    v_exp_f32 v98, v98
    v_exp_f32 v100, v100
    v_exp_f32 v102, v102
    v_exp_f32 v104, v104
    v_exp_f32 v106, v106
    v_exp_f32 v93, v93
    v_exp_f32 v95, v95
    v_exp_f32 v97, v97
    v_exp_f32 v99, v99
    v_exp_f32 v101, v101
    v_exp_f32 v103, v103
    v_exp_f32 v105, v105
    v_exp_f32 v107, v107
    v_pk_add_f32 v[92:93], v[92:93], s[74:75]
    v_pk_add_f32 v[94:95], v[94:95], s[74:75]
    v_pk_add_f32 v[96:97], v[96:97], s[74:75]
    v_pk_add_f32 v[98:99], v[98:99], s[74:75]
    v_pk_add_f32 v[100:101], v[100:101], s[74:75]
    v_pk_add_f32 v[102:103], v[102:103], s[74:75]
    v_pk_add_f32 v[104:105], v[104:105], s[74:75]
    v_pk_add_f32 v[106:107], v[106:107], s[74:75]
    v_rcp_f32 v92, v92
    v_rcp_f32 v94, v94
    v_rcp_f32 v96, v96
    v_rcp_f32 v98, v98
    v_rcp_f32 v100, v100
    v_rcp_f32 v102, v102
    v_rcp_f32 v104, v104
    v_rcp_f32 v106, v106
    v_rcp_f32 v93, v93
    v_rcp_f32 v95, v95
    v_rcp_f32 v97, v97
    v_rcp_f32 v99, v99
    v_rcp_f32 v101, v101
    v_rcp_f32 v103, v103
    v_rcp_f32 v105, v105
    v_rcp_f32 v107, v107
    v_pk_mul_f32 v[108:109], v[108:109], v[92:93]
    v_pk_mul_f32 v[110:111], v[110:111], v[94:95]
    v_pk_mul_f32 v[112:113], v[112:113], v[96:97]
    v_pk_mul_f32 v[114:115], v[114:115], v[98:99]
    v_pk_mul_f32 v[116:117], v[116:117], v[100:101]
    v_pk_mul_f32 v[118:119], v[118:119], v[102:103]
    v_pk_mul_f32 v[120:121], v[120:121], v[104:105]
    v_pk_mul_f32 v[122:123], v[122:123], v[106:107]
    v_cvt_pk_bf16_f32 v92, v108, v109
    v_cvt_pk_bf16_f32 v94, v110, v111
    v_cvt_pk_bf16_f32 v96, v112, v113
    v_cvt_pk_bf16_f32 v98, v114, v115
    v_cvt_pk_bf16_f32 v100, v116, v117
    v_cvt_pk_bf16_f32 v102, v118, v119
    v_cvt_pk_bf16_f32 v104, v120, v121
    v_cvt_pk_bf16_f32 v106, v122, v123
    v_lshlrev_b32 v108, 16, v92
    v_lshlrev_b32 v110, 16, v94
    v_lshlrev_b32 v112, 16, v96
    v_lshlrev_b32 v114, 16, v98
    v_lshlrev_b32 v116, 16, v100
    v_lshlrev_b32 v118, 16, v102
    v_lshlrev_b32 v120, 16, v104
    v_lshlrev_b32 v122, 16, v106
    v_and_b32 v109, s57, v92
    v_and_b32 v111, s57, v94
    v_and_b32 v113, s57, v96
    v_and_b32 v115, s57, v98
    v_and_b32 v117, s57, v100
    v_and_b32 v119, s57, v102
    v_and_b32 v121, s57, v104
    v_and_b32 v123, s57, v106
    v_add_u32 v7, 128, v2
    v_mov_b32 v6, 0
    s_add_u32 s42, s36, 1310720
    s_addc_u32 s43, s37, 0
    s_cmp_eq_u32 s68, 4
    s_cbranch_scc1 L_b3
L_kr:
    ds_read_b32 v25, v6 offset:60232
    s_waitcnt lgkmcnt(0)
    v_readfirstlane_b32 s73, v25
    s_nop 0
    s_cmp_ge_u32 s73, 1
    s_cbranch_scc1 L_kr_ok
    s_sleep 1
    s_sub_u32 s58, s58, 1
    s_cmp_lg_u32 s58, 0
    s_cbranch_scc1 L_kr
L_kr_ok:
    s_mov_b32 s58, 2000000
    ds_read_b128 v[60:63], v5 offset:29184
    ds_read_b128 v[64:67], v5 offset:30208
    ds_read_b128 v[68:71], v5 offset:31232
    ds_read_b128 v[72:75], v5 offset:32256
    ds_read_b128 v[76:79], v5 offset:33280
    ds_read_b128 v[80:83], v5 offset:34304
    ds_read_b128 v[84:87], v5 offset:35328
    ds_read_b128 v[88:91], v5 offset:36352
L_DMA:
    s_add_u32 s42, s36, 1310720
    s_addc_u32 s43, s37, 0
    s_lshl_b32 s76, s50, 4
    s_add_u32 s76, s76, s54
    s_mul_i32 s76, s76, 114688
    s_mul_i32 s75, s49, 7
    s_add_u32 s75, s75, s45
    s_lshl_b32 s75, s75, 7
    s_add_u32 s76, s76, s75
    s_add_u32 s67, s76, 1310720
    s_mul_i32 s65, s45, 8208
    v_lshrrev_b32 v5, 3, v1
    v_mul_u32_u24 v5, 1792, v5
    v_and_b32 v24, 7, v1
    v_lshl_add_u32 v5, v24, 4, v5
    v_lshl_add_u32 v24, v1, 4, s65
    s_cmp_ge_u32 s2, 107
    s_cselect_b32 s27, 11, 10
    s_cmp_ge_u32 s2, 135
    s_cselect_b32 s27, 12, s27
    v_mov_b32 v6, 0
    s_waitcnt vmcnt(0) lgkmcnt(0)
    v_mov_b32 v25, 1
    s_mov_b64 exec, 1
    ds_add_u32 v6, v25 offset:60204
    s_mov_b64 exec, -1
    s_setprio 2
    s_cmp_ge_u32 s45, 7
    s_cbranch_scc1 L_nodma
L_b2:
    ds_read_b32 v25, v6 offset:60204
    s_waitcnt lgkmcnt(0)
    v_readfirstlane_b32 s73, v25
    s_nop 0
    s_cmp_ge_u32 s73, s27
    s_cbranch_scc1 L_b2_ok
    s_sleep 0
    s_sub_u32 s58, s58, 1
    s_cmp_lg_u32 s58, 0
    s_cbranch_scc1 L_b2
L_b2_ok:
    s_mov_b32 s58, 2000000
    s_mov_b32 s66, s65
    s_mov_b32 s69, s67
    s_mov_b32 s31, 0x10001
    s_mov_b32 m0, s66
    s_add_u32 s66, s66, 1024
    buffer_load_dwordx4 v5, s[60:63], s69 offen sc1 lds
    s_add_u32 s69, s69, 14336
    s_mov_b32 m0, s66
    s_add_u32 s66, s66, 1024
    buffer_load_dwordx4 v5, s[60:63], s69 offen sc1 lds
    s_add_u32 s69, s69, 14336
    s_mov_b32 m0, s66
    s_add_u32 s66, s66, 1024
    buffer_load_dwordx4 v5, s[60:63], s69 offen sc1 lds
    s_add_u32 s69, s69, 14336
    s_mov_b32 m0, s66
    s_add_u32 s66, s66, 1024
    buffer_load_dwordx4 v5, s[60:63], s69 offen sc1 lds
    s_add_u32 s69, s69, 14336
    s_mov_b32 m0, s66
    s_add_u32 s66, s66, 1024
    buffer_load_dwordx4 v5, s[60:63], s69 offen sc1 lds
    s_add_u32 s69, s69, 14336
    s_waitcnt vmcnt(4)
    s_mov_b32 m0, s66
    s_add_u32 s66, s66, 1024
    buffer_load_dwordx4 v5, s[60:63], s69 offen sc1 lds
    s_add_u32 s69, s69, 14336
    ds_read_b128 v[28:31], v24 offset:0
    s_waitcnt vmcnt(4)
    s_mov_b32 m0, s66
    s_add_u32 s66, s66, 1024
    buffer_load_dwordx4 v5, s[60:63], s69 offen sc1 lds
    s_add_u32 s69, s69, 14336
    ds_read_b128 v[32:35], v24 offset:1024
    s_waitcnt vmcnt(4)
    s_mov_b32 m0, s66
    s_add_u32 s66, s66, 1024
    buffer_load_dwordx4 v5, s[60:63], s69 offen sc1 lds
    s_add_u32 s69, s69, 14336
    ds_read_b128 v[36:39], v24 offset:2048
    s_waitcnt vmcnt(4)
    ds_read_b128 v[40:43], v24 offset:3072
    s_waitcnt lgkmcnt(0)
    v_xor_b32 v25, s44, v31
    v_bitop3_b32 v25, v25, v35, s44 bitop3:0xf6
    v_bitop3_b32 v25, v25, v39, s44 bitop3:0xf6
    v_bitop3_b32 v25, v25, v43, s44 bitop3:0xf6
    v_cmp_ne_u32 vcc, 0, v25
    s_cbranch_vccnz L_noearly
    v_mov_b32 v25, 0x10000
    s_mov_b64 exec, 1
    ds_add_u32 v6, v25 offset:60208
    s_mov_b64 exec, -1
    s_mov_b32 s31, 1
L_noearly:
    s_waitcnt vmcnt(3)
    ds_read_b128 v[44:47], v24 offset:4096
    s_waitcnt vmcnt(2)
    ds_read_b128 v[48:51], v24 offset:5120
    s_waitcnt vmcnt(1)
    ds_read_b128 v[52:55], v24 offset:6144
    s_waitcnt vmcnt(0)
    ds_read_b128 v[56:59], v24 offset:7168
L_DMAchk:
    s_waitcnt lgkmcnt(7)
    v_cmp_ne_u32 s[4:5], s44, v31
    s_waitcnt lgkmcnt(6)
    v_cmp_ne_u32 s[6:7], s44, v35
    s_waitcnt lgkmcnt(5)
    v_cmp_ne_u32 s[8:9], s44, v39
    s_waitcnt lgkmcnt(4)
    v_cmp_ne_u32 s[10:11], s44, v43
    s_waitcnt lgkmcnt(3)
    v_cmp_ne_u32 s[12:13], s44, v47
    s_waitcnt lgkmcnt(2)
    v_cmp_ne_u32 s[14:15], s44, v51
    s_waitcnt lgkmcnt(1)
    v_cmp_ne_u32 s[16:17], s44, v55
    s_waitcnt lgkmcnt(0)
    v_cmp_ne_u32 s[18:19], s44, v59
    s_or_b64 s[74:75], s[4:5], s[6:7]
    s_or_b64 s[76:77], s[8:9], s[10:11]
    s_or_b64 s[78:79], s[12:13], s[14:15]
    s_or_b64 s[74:75], s[74:75], s[76:77]
    s_or_b64 s[76:77], s[16:17], s[18:19]
    s_or_b64 s[74:75], s[74:75], s[78:79]
    s_or_b64 s[74:75], s[74:75], s[76:77]
    s_cbranch_scc1 L_DMAretry
L_DMAok:
    v_mov_b32 v25, s31
    s_mov_b64 exec, 1
    ds_add_u32 v6, v25 offset:60208
    s_mov_b64 exec, -1
L_nodma:
    s_sub_u32 s73, s45, 4
    s_cmp_lt_u32 s73, 4
    s_cbranch_scc1 L_helper
L_b3:
    ds_read_b32 v25, v6 offset:60208
    s_waitcnt lgkmcnt(0)
    v_readfirstlane_b32 s73, v25
    s_nop 0
    s_cmp_ge_u32 s73, 458752
    s_cbranch_scc1 L_b3_ok
    s_sleep 0
    s_sub_u32 s58, s58, 1
    s_cmp_lg_u32 s58, 0
    s_cbranch_scc1 L_b3
L_b3_ok:
    s_mov_b32 s58, 2000000
    s_setprio 3
    ds_read_b64 v[26:27], v6 offset:58896
    ds_read2st64_b32 v[28:29], v2 offset0:0 offset1:1
    ds_read2st64_b32 v[30:31], v7 offset0:0 offset1:1
    ds_read2st64_b32 v[32:33], v2 offset0:4 offset1:5
    ds_read2st64_b32 v[34:35], v7 offset0:4 offset1:5
    ds_read2st64_b32 v[36:37], v2 offset0:8 offset1:9
    ds_read2st64_b32 v[38:39], v7 offset0:8 offset1:9
    ds_read2st64_b32 v[40:41], v2 offset0:12 offset1:13
    ds_read2st64_b32 v[42:43], v7 offset0:12 offset1:13
    s_cmp_eq_u32 s54, 0
    s_cbranch_scc1 L_conj
    s_waitcnt lgkmcnt(6)
    v_readfirstlane_b32 s64, v26
    v_readfirstlane_b32 s65, v27
    v_mfma_f32_32x32x16_bf16 v[92:107], v[28:31], v[60:63], 0
    s_waitcnt lgkmcnt(4)
    v_mfma_f32_32x32x16_bf16 v[92:107], v[32:35], v[64:67], v[92:107]
    s_waitcnt lgkmcnt(2)
    v_mfma_f32_32x32x16_bf16 v[92:107], v[36:39], v[68:71], v[92:107]
    s_waitcnt lgkmcnt(0)
    v_mfma_f32_32x32x16_bf16 v[92:107], v[40:43], v[72:75], v[92:107]
L_b4a:
    ds_read_b32 v25, v6 offset:60208
    s_waitcnt lgkmcnt(0)
    v_readfirstlane_b32 s73, v25
    s_nop 0
    s_cmp_ge_u32 s73, 458759
    s_cbranch_scc1 L_b4a_ok
    s_sub_u32 s58, s58, 1
    s_cmp_lg_u32 s58, 0
    s_cbranch_scc1 L_b4a
L_b4a_ok:
    s_mov_b32 s58, 2000000
    ds_read2st64_b32 v[44:45], v2 offset0:16 offset1:17
    ds_read2st64_b32 v[46:47], v7 offset0:16 offset1:17
    ds_read2st64_b32 v[48:49], v2 offset0:20 offset1:21
    ds_read2st64_b32 v[50:51], v7 offset0:20 offset1:21
    ds_read2st64_b32 v[52:53], v2 offset0:24 offset1:25
    ds_read2st64_b32 v[54:55], v7 offset0:24 offset1:25
    ds_read2st64_b32 v[56:57], v2 offset0:28 offset1:29
    ds_read2st64_b32 v[58:59], v7 offset0:28 offset1:29
    s_waitcnt lgkmcnt(6)
    v_mfma_f32_32x32x16_bf16 v[92:107], v[44:47], v[76:79], v[92:107]
    s_waitcnt lgkmcnt(4)
    v_mfma_f32_32x32x16_bf16 v[92:107], v[48:51], v[80:83], v[92:107]
    s_waitcnt lgkmcnt(2)
    v_mfma_f32_32x32x16_bf16 v[92:107], v[52:55], v[84:87], v[92:107]
    s_waitcnt lgkmcnt(0)
    v_mfma_f32_32x32x16_bf16 v[92:107], v[56:59], v[88:91], v[92:107]
L_mfdone:
    s_andn2_b32 s73, 63, s64
    s_andn2_b32 s74, 63, s65
    s_mov_b64 s[76:77], -1
    s_mov_b64 s[78:79], -1
    s_cmp_eq_u32 s73, s46
    s_cbranch_scc1 L_fin
    s_cmp_eq_u32 s74, s46
    s_cbranch_scc1 L_fin
L_ep:
    s_nop 3
    v_fma_f32 v108, v92, v108, v8
    v_fma_f32 v109, v93, v109, v9
    v_fma_f32 v110, v94, v110, v10
    v_fma_f32 v111, v95, v111, v11
    v_fma_f32 v112, v96, v112, v12
    v_fma_f32 v113, v97, v113, v13
    v_fma_f32 v114, v98, v114, v14
    v_fma_f32 v115, v99, v115, v15
    v_fma_f32 v116, v100, v116, v16
    v_fma_f32 v117, v101, v117, v17
    v_fma_f32 v118, v102, v118, v18
    v_fma_f32 v119, v103, v119, v19
    v_fma_f32 v120, v104, v120, v20
    v_fma_f32 v121, v105, v121, v21
    v_fma_f32 v122, v106, v122, v22
    v_fma_f32 v123, v107, v123, v23
    v_cvt_pk_bf16_f32 v60, v108, v109
    v_cvt_pk_bf16_f32 v64, v116, v117
    v_cvt_pk_bf16_f32 v61, v110, v111
    v_cvt_pk_bf16_f32 v65, v118, v119
    v_cvt_pk_bf16_f32 v62, v112, v113
    v_cvt_pk_bf16_f32 v66, v120, v121
    v_cvt_pk_bf16_f32 v63, v114, v115
    v_cvt_pk_bf16_f32 v67, v122, v123
    v_permlane16_swap_b32 v60, v64
    v_permlane16_swap_b32 v61, v65
    v_permlane16_swap_b32 v62, v66
    v_permlane16_swap_b32 v63, v67
L_st:
    s_mov_b64 exec, s[76:77]
    global_store_dwordx4 v0, v[60:63], s[36:37] nt
    s_mov_b64 exec, s[78:79]
    global_store_dwordx4 v0, v[64:67], s[42:43] nt
    s_endpgm
L_fin:
    s_lshl_b32 s23, s68, 8
    v_lshrrev_b32 v5, 5, v1
    v_lshl_add_u32 v5, v5, 6, s23
    s_lshl_b32 s23, s68, 2
    v_mov_b32 v24, s23
    v_mov_b32 v25, 1
    s_nop 4
    s_cmp_lg_u32 s73, s46
    s_cbranch_scc1 L_fs0
    s_not_b32 s75, s64
    s_bfe_u32 s75, s75, 0x50006
    s_lshl_b32 s75, 1, s75
    s_mov_b32 exec_lo, s75
    s_mov_b32 exec_hi, s75
    ds_write_b128 v5, v[92:95] offset:58912
    ds_write_b128 v5, v[96:99] offset:58928
    ds_write_b128 v5, v[100:103] offset:58944
    ds_write_b128 v5, v[104:107] offset:58960
L_fs0:
    s_cmp_lg_u32 s74, s46
    s_cbranch_scc1 L_fs1
    s_not_b32 s75, s65
    s_bfe_u32 s75, s75, 0x50006
    s_lshl_b32 s75, 1, s75
    s_mov_b32 exec_lo, s75
    s_mov_b32 exec_hi, s75
    ds_write_b128 v5, v[92:95] offset:59040
    ds_write_b128 v5, v[96:99] offset:59056
    ds_write_b128 v5, v[100:103] offset:59072
    ds_write_b128 v5, v[104:107] offset:59088
L_fs1:
    ds_write_b32 v24, v25 offset:60212
    s_mov_b64 exec, -1
    s_andn2_b32 s73, 0x7ff, s64
    s_andn2_b32 s74, 0x7ff, s65
    v_add_u32 v5, 1024, v4
    v_cmp_ne_u32 vcc, s73, v4
    v_cmp_ne_u32 s[76:77], s74, v4
    v_cmp_ne_u32 s[78:79], s73, v5
    v_cmp_ne_u32 s[70:71], s74, v5
    s_and_b64 s[76:77], vcc, s[76:77]
    s_and_b64 s[78:79], s[70:71], s[78:79]
    s_branch L_ep
L_hprep:
    v_mov_b32 v6, 0
    v_mov_b32 v60, 0
    v_mov_b32 v61, 0
    ds_read_b64 v[24:25], v6 offset:58896
    s_sub_u32 s68, s45, 4
    s_mov_b32 s24, 0
    s_cmp_ge_u32 s45, 7
    s_cselect_b32 s33, 1, 0
    s_waitcnt lgkmcnt(0)
    v_readfirstlane_b32 s28, v24
    v_readfirstlane_b32 s29, v25
    s_andn2_b32 s26, 63, s28
    s_andn2_b32 s30, 63, s29
    s_cmp_eq_u32 s26, s46
    s_cbranch_scc1 L_h1
    s_cmp_eq_u32 s30, s46
    s_cbranch_scc0 L_hret
L_h1:
    s_mov_b32 s24, 1
    s_lshl_b32 s74, s49, 4
    s_add_u32 s74, s74, s56
    s_and_b32 s75, s68, 1
    s_lshl_b32 s75, s75, 5
    s_add_u32 s74, s74, s75
    s_sub_u32 s75, 608, s74
    s_cmp_ge_u32 s68, 2
    s_cselect_b32 s74, s75, s74
    s_add_u32 s75, s74, 16
    s_lshl_b32 s76, s49, 6
    s_sub_u32 s73, s56, s76
    s_add_u32 s73, s73, 64
    s_sub_u32 s76, 624, s73
    s_cmp_eq_u32 s68, 4
    s_cselect_b32 s20, s73, s74
    s_cselect_b32 s21, s76, s75
    v_and_b32 v28, 7, v1
    s_sub_u32 s21, s21, 16
    v_mov_b32 v68, s20
    v_mov_b32 v29, s21
    s_mov_b32 s76, 0xf0f0f0f0
    s_mov_b32 s77, 0xf0f0f0f0
    v_cndmask_b32 v68, v68, v29, s[76:77]
    v_lshl_add_u32 v68, v28, 2, v68
    v_lshrrev_b32 v60, 7, v68
    v_mul_u32_u24 v60, 27, v60
    v_lshrrev_b32 v29, 3, v1
    v_add_u32 v60, v60, v29
    v_lshlrev_b32 v60, 10, v60
    v_and_b32 v30, 127, v68
    v_lshl_add_u32 v60, v30, 2, v60
    v_lshrrev_b32 v29, 4, v1
    v_add_u32 v68, v68, v29
    v_lshl_add_u32 v28, v28, 2, v29
    s_lshl_b32 s23, s68, 8
    v_lshl_add_u32 v67, v28, 2, s23
    v_lshlrev_b32 v68, 1, v68
    v_mov_b32 v69, v68
    s_lshl_b32 s23, s68, 2
    v_mov_b32 v70, s23
    s_mov_b32 s22, 0
L_hx:
    ds_read_b32 v25, v6 offset:60200
    s_waitcnt lgkmcnt(0)
    v_readfirstlane_b32 s73, v25
    s_nop 0
    s_cmp_ge_u32 s73, 1
    s_cbranch_scc1 L_hx_ok
    s_sleep 1
    s_sub_u32 s58, s58, 1
    s_cmp_lg_u32 s58, 0
    s_cbranch_scc1 L_hx
L_hx_ok:
    s_mov_b32 s58, 2000000
    s_cmp_eq_u32 s26, s46
    s_cbranch_scc1 L_htok
L_htok1:
    s_mov_b32 s28, s29
    s_movk_i32 s22, 512
    v_add_u32 v69, 1280, v69
    v_add_u32 v67, 128, v67
L_htok:
    s_andn2_b32 s73, 0x7ff, s28
    s_lshr_b32 s74, s73, 6
    s_lshl_b32 s74, s74, 3
    v_mov_b32 v28, s74
    ds_read_u16 v64, v69 offset:60512
    ds_read_b64 v[28:29], v28 offset:58368
    s_mul_i32 s73, s73, 1280
    v_add_u32 v61, s73, v68
    s_and_b32 s74, s28, 0xfffff800
    s_or_b32 s74, s74, 0x400
    s_not_b32 s75, s74
    s_ashr_i32 s75, s75, 31
    s_or_b32 s75, s75, 0x80000000
    s_xor_b32 s74, s74, s75
    v_mov_b32 v66, s74
    v_cvt_pk_bf16_f32 v66, v66, v66
    v_lshlrev_b32 v66, 16, v66
    v_mul_f32 v66, 0xbfb8aa3b, v66
    v_exp_f32 v66, v66
    s_nop 0
    v_add_f32 v66, 1.0, v66
    v_rcp_f32 v66, v66
    s_nop 0
    v_cvt_pk_bf16_f32 v66, v66, v66
    v_lshlrev_b32 v66, 16, v66
    s_waitcnt lgkmcnt(0)
    v_lshlrev_b32 v64, 16, v64
    v_sub_f32 v62, v64, v28
    v_cvt_pk_bf16_f32 v62, v62, v62
    v_lshlrev_b32 v62, 16, v62
    v_mul_f32 v62, v62, v29
    v_cvt_pk_bf16_f32 v62, v62, v62
    v_lshlrev_b32 v62, 16, v62
    s_cmp_eq_u32 s24, 2
    s_cbranch_scc1 L_helper
L_hret:
    s_cmp_lg_u32 s45, 8
    s_cbranch_scc1 L_DMA
L_helper:
    s_cmp_eq_u32 s24, 0
    s_cbranch_scc1 L_helper_end
    v_mov_b32 v44, 0
    v_mov_b32 v45, 0
    v_mov_b32 v46, 0
    v_mov_b32 v47, s44
    s_mov_b32 s25, 0
    s_mov_b32 s8, 0xffffff
    s_mov_b32 s9, 0
    s_mov_b32 s10, 0x0c04000c
    s_mov_b32 s11, 0x04020100
    s_cmp_eq_u32 s33, 1
    s_cbranch_scc1 L_hpoll0
L_hb3:
    ds_read_b32 v25, v6 offset:60208
    s_waitcnt lgkmcnt(0)
    v_readfirstlane_b32 s73, v25
    s_nop 0
    s_cmp_ge_u32 s73, 458759
    s_cbranch_scc1 L_hb3_ok
    s_sleep 1
    s_sub_u32 s58, s58, 1
    s_cmp_lg_u32 s58, 0
    s_cbranch_scc1 L_hb3
L_hb3_ok:
    s_mov_b32 s58, 2000000
L_hpoll0:
    s_mov_b64 vcc, -1
    s_setprio 3
L_hpoll:
    s_mov_b64 exec, vcc
    s_add_u32 s4, s22, s25
    s_add_u32 s4, s4, 851968
    s_add_u32 s5, s4, 8192
    s_add_u32 s6, s4, 16384
    s_add_u32 s7, s4, 24576
    s_xor_b32 s25, s25, 138496
    s_cmp_eq_u32 s33, 1
    s_cbranch_scc1 L_yz
    buffer_load_dwordx4 v[32:35], v60, s[60:63], s4 offen sc1
    buffer_load_dwordx4 v[36:39], v60, s[60:63], s5 offen sc1
    buffer_load_dwordx4 v[40:43], v60, s[60:63], s6 offen sc1
    s_and_b64 exec, exec, s[8:9]
    s_cbranch_execz L_yz
    buffer_load_dwordx4 v[44:47], v60, s[60:63], s7 offen sc1
L_yz:
    s_mov_b64 exec, -1
    s_waitcnt vmcnt(0)
    v_xor_b32 v28, s44, v35
    v_bitop3_b32 v28, v28, v39, s44 bitop3:0xf6
    v_bitop3_b32 v28, v28, v43, s44 bitop3:0xf6
    v_bitop3_b32 v28, v28, v47, s44 bitop3:0xf6
    v_cmp_ne_u32 vcc, 0, v28
    s_cbranch_vccz L_hok
    s_cmp_eq_u32 s33, 1
    s_cbranch_scc1 L_hok
    s_sleep 1
    s_sub_u32 s58, s58, 1
    s_cmp_lg_u32 s58, 0
    s_cbranch_scc1 L_hpoll
L_hok:
    ds_read_b32 v25, v70 offset:60212
    ds_read_b32 v26, v67 offset:58912
    v_perm_b32 v35, v33, v32, s10
    v_perm_b32 v39, v37, v36, s10
    v_perm_b32 v43, v41, v40, s10
    v_perm_b32 v47, v45, v44, s10
    v_perm_b32 v35, v34, v35, s11
    v_perm_b32 v39, v38, v39, s11
    v_perm_b32 v43, v42, v43, s11
    v_perm_b32 v47, v46, v47, s11
    v_add_f32 v32, v32, v36
    v_add_f32 v33, v33, v37
    v_add_f32 v34, v34, v38
    v_add_f32 v35, v35, v39
    v_add_f32 v40, v40, v44
    v_add_f32 v41, v41, v45
    v_add_f32 v42, v42, v46
    v_add_f32 v43, v43, v47
    v_add_f32 v32, v32, v40
    v_add_f32 v33, v33, v41
    v_add_f32 v34, v34, v42
    v_add_f32 v35, v35, v43
    v_add_f32_dpp v32, v32, v32 row_ror:8 row_mask:0xf bank_mask:0xf
    v_add_f32_dpp v33, v33, v33 row_ror:8 row_mask:0xf bank_mask:0xf
    v_add_f32_dpp v34, v34, v34 row_ror:8 row_mask:0xf bank_mask:0xf
    v_add_f32_dpp v35, v35, v35 row_ror:8 row_mask:0xf bank_mask:0xf
    v_permlane16_swap_b32 v32, v33
    s_nop 0
    v_permlane16_swap_b32 v34, v35
    v_add_f32 v32, v32, v33
    v_add_f32 v34, v34, v35
    s_nop 1
    v_permlane32_swap_b32 v32, v34
    v_add_f32 v32, v32, v34
    v_cvt_pk_bf16_f32 v32, v32, v32
    v_lshlrev_b32 v32, 16, v32
    v_mul_f32 v32, v32, v66
    v_cvt_pk_bf16_f32 v32, v32, v32
    v_lshlrev_b32 v32, 16, v32
    v_add_f32 v32, v32, v62
    v_cvt_pk_bf16_f32 v32, v32, v32
    v_lshlrev_b32 v32, 16, v32
    v_mul_f32 v28, 0xbfb8aa3b, v32
    v_exp_f32 v28, v28
    s_nop 0
    v_add_f32 v28, 1.0, v28
    v_rcp_f32 v28, v28
    s_nop 0
    v_mul_f32 v32, v32, v28
    v_cvt_pk_bf16_f32 v32, v32, v32
    v_lshlrev_b32 v32, 16, v32
    s_cmp_eq_u32 s33, 1
    s_mov_b32 s33, 0
    s_cbranch_scc1 L_helper
L_hs:
    s_waitcnt lgkmcnt(0)
    v_readfirstlane_b32 s73, v25
    s_nop 0
    s_cmp_eq_u32 s73, 0
    s_cbranch_scc1 L_hs2
    v_fma_f32 v28, v32, v26, v64
    v_cvt_pk_bf16_f32 v31, v28, v28
    s_mov_b32 exec_lo, 0x00ff00ff
    s_mov_b32 exec_hi, 0x00ff00ff
    global_store_short v61, v31, s[36:37]
    s_mov_b64 exec, -1
    s_mov_b32 s24, 2
    s_cmp_lg_u32 s22, 0
    s_cbranch_scc1 L_hdone
    s_cmp_eq_u32 s30, s46
    s_cbranch_scc1 L_htok1
L_hdone:
L_helper_end:
    s_endpgm
L_hs2:
    ds_read_b32 v25, v70 offset:60212
    ds_read_b32 v26, v67 offset:58912
    s_sub_u32 s58, s58, 1
    s_cmp_lg_u32 s58, 0
    s_cbranch_scc1 L_hs
    s_endpgm
L_DMAretry:
    s_sleep 1
    s_sub_u32 s58, s58, 1
    s_cmp_eq_u32 s58, 0
    s_cbranch_scc1 L_DMAok
    s_mov_b32 s66, s65
    s_mov_b32 s69, s67
    s_mov_b32 m0, s66
    s_mov_b64 exec, s[4:5]
    s_cbranch_execz L_dr0
    buffer_load_dwordx4 v5, s[60:63], s69 offen sc1 lds
L_dr0:
    s_add_u32 s66, s66, 1024
    s_add_u32 s69, s69, 14336
    s_mov_b32 m0, s66
    s_mov_b64 exec, s[6:7]
    s_cbranch_execz L_dr1
    buffer_load_dwordx4 v5, s[60:63], s69 offen sc1 lds
L_dr1:
    s_add_u32 s66, s66, 1024
    s_add_u32 s69, s69, 14336
    s_mov_b32 m0, s66
    s_mov_b64 exec, s[8:9]
    s_cbranch_execz L_dr2
    buffer_load_dwordx4 v5, s[60:63], s69 offen sc1 lds
L_dr2:
    s_add_u32 s66, s66, 1024
    s_add_u32 s69, s69, 14336
    s_mov_b32 m0, s66
    s_mov_b64 exec, s[10:11]
    s_cbranch_execz L_dr3
    buffer_load_dwordx4 v5, s[60:63], s69 offen sc1 lds
L_dr3:
    s_add_u32 s66, s66, 1024
    s_add_u32 s69, s69, 14336
    s_mov_b32 m0, s66
    s_mov_b64 exec, s[12:13]
    s_cbranch_execz L_dr4
    buffer_load_dwordx4 v5, s[60:63], s69 offen sc1 lds
L_dr4:
    s_add_u32 s66, s66, 1024
    s_add_u32 s69, s69, 14336
    s_mov_b32 m0, s66
    s_mov_b64 exec, s[14:15]
    s_cbranch_execz L_dr5
    buffer_load_dwordx4 v5, s[60:63], s69 offen sc1 lds
L_dr5:
    s_add_u32 s66, s66, 1024
    s_add_u32 s69, s69, 14336
    s_mov_b32 m0, s66
    s_mov_b64 exec, s[16:17]
    s_cbranch_execz L_dr6
    buffer_load_dwordx4 v5, s[60:63], s69 offen sc1 lds
L_dr6:
    s_add_u32 s66, s66, 1024
    s_add_u32 s69, s69, 14336
    s_mov_b32 m0, s66
    s_mov_b64 exec, s[18:19]
    s_cbranch_execz L_dr7
    buffer_load_dwordx4 v5, s[60:63], s69 offen sc1 lds
L_dr7:
    s_add_u32 s66, s66, 1024
    s_add_u32 s69, s69, 14336
    s_mov_b64 exec, -1
    s_waitcnt vmcnt(0)
    ds_read_b128 v[28:31], v24 offset:0
    ds_read_b128 v[32:35], v24 offset:1024
    ds_read_b128 v[36:39], v24 offset:2048
    ds_read_b128 v[40:43], v24 offset:3072
    ds_read_b128 v[44:47], v24 offset:4096
    ds_read_b128 v[48:51], v24 offset:5120
    ds_read_b128 v[52:55], v24 offset:6144
    ds_read_b128 v[56:59], v24 offset:7168
    s_branch L_DMAchk
L_np:
    s_waitcnt vmcnt(15)
    v_dot2c_f32_bf16 v112, s55, v8
    v_dot2c_f32_bf16 v114, v8, v8
    ds_write_b128 v6, v[8:11] offset:37376
    v_dot2c_f32_bf16 v112, s55, v9
    v_dot2c_f32_bf16 v114, v9, v9
    v_dot2c_f32_bf16 v112, s55, v10
    v_dot2c_f32_bf16 v114, v10, v10
    v_dot2c_f32_bf16 v112, s55, v11
    v_dot2c_f32_bf16 v114, v11, v11
    s_waitcnt vmcnt(14)
    v_dot2c_f32_bf16 v112, s55, v12
    v_dot2c_f32_bf16 v114, v12, v12
    v_dot2c_f32_bf16 v112, s55, v13
    v_dot2c_f32_bf16 v114, v13, v13
    v_dot2c_f32_bf16 v112, s55, v14
    v_dot2c_f32_bf16 v114, v14, v14
    v_dot2c_f32_bf16 v112, s55, v15
    v_dot2c_f32_bf16 v114, v15, v15
    s_waitcnt vmcnt(13)
    v_dot2c_f32_bf16 v112, s55, v16
    v_dot2c_f32_bf16 v114, v16, v16
    ds_write_b128 v68, v[16:19] offset:37760
    v_dot2c_f32_bf16 v112, s55, v17
    v_dot2c_f32_bf16 v114, v17, v17
    v_dot2c_f32_bf16 v112, s55, v18
    v_dot2c_f32_bf16 v114, v18, v18
    v_dot2c_f32_bf16 v112, s55, v19
    v_dot2c_f32_bf16 v114, v19, v19
    s_waitcnt vmcnt(12)
    v_dot2c_f32_bf16 v112, s55, v20
    v_dot2c_f32_bf16 v114, v20, v20
    v_dot2c_f32_bf16 v112, s55, v21
    v_dot2c_f32_bf16 v114, v21, v21
    v_dot2c_f32_bf16 v112, s55, v22
    v_dot2c_f32_bf16 v114, v22, v22
    v_dot2c_f32_bf16 v112, s55, v23
    v_dot2c_f32_bf16 v114, v23, v23
    s_waitcnt vmcnt(8)
    v_dot2c_f32_bf16 v112, s55, v24
    v_dot2c_f32_bf16 v114, v24, v24
    ds_write_b32 v7, v24 offset:37632
    v_dot2c_f32_bf16 v112, s55, v25
    v_dot2c_f32_bf16 v114, v25, v25
    ds_write_b32 v69, v26 offset:37696
    v_dot2c_f32_bf16 v112, s55, v26
    v_dot2c_f32_bf16 v114, v26, v26
    v_dot2c_f32_bf16 v112, s55, v27
    v_dot2c_f32_bf16 v114, v27, v27
    s_waitcnt vmcnt(7)
    v_dot2c_f32_bf16 v116, s55, v28
    v_dot2c_f32_bf16 v118, v28, v28
    ds_write_b128 v6, v[28:31] offset:40000
    v_dot2c_f32_bf16 v116, s55, v29
    v_dot2c_f32_bf16 v118, v29, v29
    v_dot2c_f32_bf16 v116, s55, v30
    v_dot2c_f32_bf16 v118, v30, v30
    v_dot2c_f32_bf16 v116, s55, v31
    v_dot2c_f32_bf16 v118, v31, v31
    s_waitcnt vmcnt(6)
    v_dot2c_f32_bf16 v116, s55, v32
    v_dot2c_f32_bf16 v118, v32, v32
    v_dot2c_f32_bf16 v116, s55, v33
    v_dot2c_f32_bf16 v118, v33, v33
    v_dot2c_f32_bf16 v116, s55, v34
    v_dot2c_f32_bf16 v118, v34, v34
    v_dot2c_f32_bf16 v116, s55, v35
    v_dot2c_f32_bf16 v118, v35, v35
    s_waitcnt vmcnt(5)
    v_dot2c_f32_bf16 v116, s55, v36
    v_dot2c_f32_bf16 v118, v36, v36
    ds_write_b128 v68, v[36:39] offset:40384
    v_dot2c_f32_bf16 v116, s55, v37
    v_dot2c_f32_bf16 v118, v37, v37
    v_dot2c_f32_bf16 v116, s55, v38
    v_dot2c_f32_bf16 v118, v38, v38
    v_dot2c_f32_bf16 v116, s55, v39
    v_dot2c_f32_bf16 v118, v39, v39
    s_waitcnt vmcnt(4)
    v_dot2c_f32_bf16 v116, s55, v40
    v_dot2c_f32_bf16 v118, v40, v40
    v_dot2c_f32_bf16 v116, s55, v41
    v_dot2c_f32_bf16 v118, v41, v41
    v_dot2c_f32_bf16 v116, s55, v42
    v_dot2c_f32_bf16 v118, v42, v42
    v_dot2c_f32_bf16 v116, s55, v43
    v_dot2c_f32_bf16 v118, v43, v43
    s_waitcnt vmcnt(0)
    v_dot2c_f32_bf16 v116, s55, v44
    v_dot2c_f32_bf16 v118, v44, v44
    ds_write_b32 v7, v44 offset:40256
    v_dot2c_f32_bf16 v116, s55, v45
    v_dot2c_f32_bf16 v118, v45, v45
    ds_write_b32 v69, v46 offset:40320
    v_dot2c_f32_bf16 v116, s55, v46
    v_dot2c_f32_bf16 v118, v46, v46
    v_dot2c_f32_bf16 v116, s55, v47
    v_dot2c_f32_bf16 v118, v47, v47
    s_waitcnt vmcnt(0)
    v_mfma_f32_32x32x16_bf16 v[72:87], v[48:51], v[8:11], 0
    v_add_f32_dpp v112, v112, v112 row_ror:8 row_mask:0xf bank_mask:0xf
    v_add_f32_dpp v114, v114, v114 row_ror:8 row_mask:0xf bank_mask:0xf
    s_nop 0
    v_add_f32_dpp v112, v116, v116 row_ror:8 row_mask:0xf bank_mask:0xc
    v_mfma_f32_32x32x16_bf16 v[72:87], v[52:55], v[12:15], v[72:87]
    v_add_f32_dpp v114, v118, v118 row_ror:8 row_mask:0xf bank_mask:0xc
    v_add_f32_dpp v112, v112, v112 row_half_mirror row_mask:0xf bank_mask:0xf
    s_nop 0
    v_add_f32_dpp v114, v114, v114 row_half_mirror row_mask:0xf bank_mask:0xf
    v_mfma_f32_32x32x16_bf16 v[72:87], v[56:59], v[16:19], v[72:87]
    v_add_f32_dpp v112, v112, v112 quad_perm:[2,3,0,1] row_mask:0xf bank_mask:0xf
    v_add_f32_dpp v114, v114, v114 quad_perm:[2,3,0,1] row_mask:0xf bank_mask:0xf
    s_nop 0
    v_add_f32_dpp v112, v112, v112 quad_perm:[1,0,3,2] row_mask:0xf bank_mask:0xf
    v_mfma_f32_32x32x16_bf16 v[72:87], v[60:63], v[20:23], v[72:87]
    v_add_f32_dpp v114, v114, v114 quad_perm:[1,0,3,2] row_mask:0xf bank_mask:0xf
    v_mul_f32 v112, 0x3acccccd, v112
    v_mul_f32 v114, 0x3acccccd, v114
    v_mfma_f32_16x16x32_bf16 v[88:91], v[64:67], v[24:27], 0
    v_cvt_pk_bf16_f32 v113, v112, v112
    v_fma_f32 v114, -v112, v112, v114
    v_lshlrev_b32 v112, 16, v113
    v_mfma_f32_32x32x16_bf16 v[92:107], v[48:51], v[28:31], 0
    v_max_f32 v114, 0, v114
    v_cvt_pk_bf16_f32 v114, v114, v114
    v_lshlrev_b32 v114, 16, v114
    v_mfma_f32_32x32x16_bf16 v[92:107], v[52:55], v[32:35], v[92:107]
    v_add_f32 v114, 0x3727c5ac, v114
    v_cvt_pk_bf16_f32 v114, v114, v114
    v_lshlrev_b32 v114, 16, v114
    v_mfma_f32_32x32x16_bf16 v[92:107], v[56:59], v[36:39], v[92:107]
    v_sqrt_f32 v114, v114
    s_nop 0
    v_cvt_pk_bf16_f32 v114, v114, v114
    v_lshlrev_b32 v114, 16, v114
    v_mfma_f32_32x32x16_bf16 v[92:107], v[60:63], v[40:43], v[92:107]
    v_rcp_f32 v113, v114
    v_mfma_f32_16x16x32_bf16 v[108:111], v[64:67], v[44:47], 0
    s_nop 7
    s_branch L_lnj
L_conj:
    s_waitcnt lgkmcnt(6)
    v_readfirstlane_b32 s64, v26
    v_readfirstlane_b32 s65, v27
    v_xor_b32 v28, v3, v28
    v_xor_b32 v29, v3, v29
    v_xor_b32 v30, v3, v30
    v_xor_b32 v31, v3, v31
    s_nop 1
    v_mfma_f32_32x32x16_bf16 v[92:107], v[28:31], v[60:63], 0
    s_waitcnt lgkmcnt(4)
    v_xor_b32 v32, v3, v32
    v_xor_b32 v33, v3, v33
    v_xor_b32 v34, v3, v34
    v_xor_b32 v35, v3, v35
    s_nop 1
    v_mfma_f32_32x32x16_bf16 v[92:107], v[32:35], v[64:67], v[92:107]
    s_waitcnt lgkmcnt(2)
    v_xor_b32 v36, v3, v36
    v_xor_b32 v37, v3, v37
    v_xor_b32 v38, v3, v38
    v_xor_b32 v39, v3, v39
    s_nop 1
    v_mfma_f32_32x32x16_bf16 v[92:107], v[36:39], v[68:71], v[92:107]
    s_waitcnt lgkmcnt(0)
    v_xor_b32 v40, v3, v40
    v_xor_b32 v41, v3, v41
    v_xor_b32 v42, v3, v42
    v_xor_b32 v43, v3, v43
    s_nop 1
    v_mfma_f32_32x32x16_bf16 v[92:107], v[40:43], v[72:75], v[92:107]
L_b4b:
    ds_read_b32 v25, v6 offset:60208
    s_waitcnt lgkmcnt(0)
    v_readfirstlane_b32 s73, v25
    s_nop 0
    s_cmp_ge_u32 s73, 458759
    s_cbranch_scc1 L_b4b_ok
    s_sub_u32 s58, s58, 1
    s_cmp_lg_u32 s58, 0
    s_cbranch_scc1 L_b4b
L_b4b_ok:
    s_mov_b32 s58, 2000000
    ds_read2st64_b32 v[44:45], v2 offset0:16 offset1:17
    ds_read2st64_b32 v[46:47], v7 offset0:16 offset1:17
    ds_read2st64_b32 v[48:49], v2 offset0:20 offset1:21
    ds_read2st64_b32 v[50:51], v7 offset0:20 offset1:21
    ds_read2st64_b32 v[52:53], v2 offset0:24 offset1:25
    ds_read2st64_b32 v[54:55], v7 offset0:24 offset1:25
    ds_read2st64_b32 v[56:57], v2 offset0:28 offset1:29
    ds_read2st64_b32 v[58:59], v7 offset0:28 offset1:29
    s_waitcnt lgkmcnt(6)
    v_xor_b32 v44, v3, v44
    v_xor_b32 v45, v3, v45
    v_xor_b32 v46, v3, v46
    v_xor_b32 v47, v3, v47
    s_nop 1
    v_mfma_f32_32x32x16_bf16 v[92:107], v[44:47], v[76:79], v[92:107]
    s_waitcnt lgkmcnt(4)
    v_xor_b32 v48, v3, v48
    v_xor_b32 v49, v3, v49
    v_xor_b32 v50, v3, v50
    v_xor_b32 v51, v3, v51
    s_nop 1
    v_mfma_f32_32x32x16_bf16 v[92:107], v[48:51], v[80:83], v[92:107]
    s_waitcnt lgkmcnt(2)
    v_xor_b32 v52, v3, v52
    v_xor_b32 v53, v3, v53
    v_xor_b32 v54, v3, v54
    v_xor_b32 v55, v3, v55
    s_nop 1
    v_mfma_f32_32x32x16_bf16 v[92:107], v[52:55], v[84:87], v[92:107]
    s_waitcnt lgkmcnt(0)
    v_xor_b32 v56, v3, v56
    v_xor_b32 v57, v3, v57
    v_xor_b32 v58, v3, v58
    v_xor_b32 v59, v3, v59
    s_nop 1
    v_mfma_f32_32x32x16_bf16 v[92:107], v[56:59], v[88:91], v[92:107]
    s_nop 10
    s_branch L_mfdone
L_A_unit:
    v_and_b32 v1, 63, v0
    s_mov_b32 s57, 0xffff0000
    s_mov_b32 s55, 0x3f803f80
    s_mov_b32 s62, 16777216
    s_mov_b32 s63, 0x20000
    s_mov_b32 s58, 2000000
    s_lshr_b32 s48, s2, 6
    s_and_b32 s49, s48, 1
    s_mul_i32 s56, s48, 80
    s_cmp_eq_u32 s45, 11
    s_cbranch_scc1 L_w12
    s_cmp_ge_u32 s45, 8
    s_cbranch_scc1 L_roleFD
    s_setprio 2
    s_sub_u32 s68, s45, 4
    s_lshr_b32 s69, s68, 1
    s_mul_i32 s69, s69, 40
    s_and_b32 s70, s68, 1
    s_mul_i32 s70, s70, 24
    s_add_u32 s69, s69, s70
    v_and_b32 v2, 31, v1
    v_lshrrev_b32 v3, 5, v1
    v_lshrrev_b32 v116, 2, v2
    v_sub_u32 v116, v2, v116
    v_add_u32 v0, s69, v116
    s_mul_i32 s69, s50, 160
    s_add_u32 s69, s69, s49
    v_lshl_add_u32 v116, v0, 1, s69
    v_cvt_f32_u32 v116, v116
    v_mul_f32 v116, 0xbacccccd, v116
    v_lshlrev_b32 v117, 3, v3
    v_cvt_f32_u32 v117, v117
    v_mul_f32 v117, v117, v116
    v_cos_f32 v84, v117
    v_sin_f32 v92, v117
    v_add_f32 v117, v117, v116
    v_cos_f32 v85, v117
    v_sin_f32 v93, v117
    v_add_f32 v117, v117, v116
    v_cos_f32 v86, v117
    v_sin_f32 v94, v117
    v_add_f32 v117, v117, v116
    v_cos_f32 v87, v117
    v_sin_f32 v95, v117
    v_add_f32 v117, v117, v116
    v_cos_f32 v88, v117
    v_sin_f32 v96, v117
    v_add_f32 v117, v117, v116
    v_cos_f32 v89, v117
    v_sin_f32 v97, v117
    v_add_f32 v117, v117, v116
    v_cos_f32 v90, v117
    v_sin_f32 v98, v117
    v_add_f32 v117, v117, v116
    v_cos_f32 v91, v117
    v_sin_f32 v99, v117
    v_mul_f32 v116, 0x41800000, v116
    v_cos_f32 v118, v116
    v_sin_f32 v120, v116
    v_mov_b32 v119, v118
    v_mov_b32 v121, v120
    v_cvt_pk_bf16_f32 v4, v84, v85
    v_cvt_pk_bf16_f32 v5, v86, v87
    v_cvt_pk_bf16_f32 v6, v88, v89
    v_cvt_pk_bf16_f32 v7, v90, v91
    v_cvt_pk_bf16_f32 v44, v92, v93
    v_cvt_pk_bf16_f32 v45, v94, v95
    v_cvt_pk_bf16_f32 v46, v96, v97
    v_cvt_pk_bf16_f32 v47, v98, v99
    v_pk_mul_f32 v[100:101], v[84:85], v[118:119]
    v_pk_mul_f32 v[108:109], v[92:93], v[118:119]
    v_pk_mul_f32 v[102:103], v[86:87], v[118:119]
    v_pk_mul_f32 v[110:111], v[94:95], v[118:119]
    v_pk_mul_f32 v[104:105], v[88:89], v[118:119]
    v_pk_mul_f32 v[112:113], v[96:97], v[118:119]
    v_pk_mul_f32 v[106:107], v[90:91], v[118:119]
    v_pk_mul_f32 v[114:115], v[98:99], v[118:119]
    v_pk_fma_f32 v[100:101], v[92:93], v[120:121], v[100:101] neg_lo:[1,0,0] neg_hi:[1,0,0]
    v_pk_fma_f32 v[108:109], v[84:85], v[120:121], v[108:109]
    v_pk_fma_f32 v[102:103], v[94:95], v[120:121], v[102:103] neg_lo:[1,0,0] neg_hi:[1,0,0]
    v_pk_fma_f32 v[110:111], v[86:87], v[120:121], v[110:111]
    v_pk_fma_f32 v[104:105], v[96:97], v[120:121], v[104:105] neg_lo:[1,0,0] neg_hi:[1,0,0]
    v_pk_fma_f32 v[112:113], v[88:89], v[120:121], v[112:113]
    v_pk_fma_f32 v[106:107], v[98:99], v[120:121], v[106:107] neg_lo:[1,0,0] neg_hi:[1,0,0]
    v_pk_fma_f32 v[114:115], v[90:91], v[120:121], v[114:115]
    v_add_f32 v118, v118, v118
    v_add_f32 v119, v119, v119
    v_cvt_pk_bf16_f32 v8, v100, v101
    v_cvt_pk_bf16_f32 v9, v102, v103
    v_cvt_pk_bf16_f32 v10, v104, v105
    v_cvt_pk_bf16_f32 v11, v106, v107
    v_cvt_pk_bf16_f32 v48, v108, v109
    v_cvt_pk_bf16_f32 v49, v110, v111
    v_cvt_pk_bf16_f32 v50, v112, v113
    v_cvt_pk_bf16_f32 v51, v114, v115
    v_pk_fma_f32 v[84:85], v[100:101], v[118:119], v[84:85] neg_lo:[0,0,1] neg_hi:[0,0,1]
    v_pk_fma_f32 v[86:87], v[102:103], v[118:119], v[86:87] neg_lo:[0,0,1] neg_hi:[0,0,1]
    v_pk_fma_f32 v[88:89], v[104:105], v[118:119], v[88:89] neg_lo:[0,0,1] neg_hi:[0,0,1]
    v_pk_fma_f32 v[90:91], v[106:107], v[118:119], v[90:91] neg_lo:[0,0,1] neg_hi:[0,0,1]
    v_pk_fma_f32 v[92:93], v[108:109], v[118:119], v[92:93] neg_lo:[0,0,1] neg_hi:[0,0,1]
    v_pk_fma_f32 v[94:95], v[110:111], v[118:119], v[94:95] neg_lo:[0,0,1] neg_hi:[0,0,1]
    v_pk_fma_f32 v[96:97], v[112:113], v[118:119], v[96:97] neg_lo:[0,0,1] neg_hi:[0,0,1]
    v_pk_fma_f32 v[98:99], v[114:115], v[118:119], v[98:99] neg_lo:[0,0,1] neg_hi:[0,0,1]
    v_cvt_pk_bf16_f32 v12, v84, v85
    v_cvt_pk_bf16_f32 v13, v86, v87
    v_cvt_pk_bf16_f32 v14, v88, v89
    v_cvt_pk_bf16_f32 v15, v90, v91
    v_cvt_pk_bf16_f32 v52, v92, v93
    v_cvt_pk_bf16_f32 v53, v94, v95
    v_cvt_pk_bf16_f32 v54, v96, v97
    v_cvt_pk_bf16_f32 v55, v98, v99
    v_pk_fma_f32 v[100:101], v[84:85], v[118:119], v[100:101] neg_lo:[0,0,1] neg_hi:[0,0,1]
    v_pk_fma_f32 v[102:103], v[86:87], v[118:119], v[102:103] neg_lo:[0,0,1] neg_hi:[0,0,1]
    v_pk_fma_f32 v[104:105], v[88:89], v[118:119], v[104:105] neg_lo:[0,0,1] neg_hi:[0,0,1]
    v_pk_fma_f32 v[106:107], v[90:91], v[118:119], v[106:107] neg_lo:[0,0,1] neg_hi:[0,0,1]
    v_pk_fma_f32 v[108:109], v[92:93], v[118:119], v[108:109] neg_lo:[0,0,1] neg_hi:[0,0,1]
    v_pk_fma_f32 v[110:111], v[94:95], v[118:119], v[110:111] neg_lo:[0,0,1] neg_hi:[0,0,1]
    v_pk_fma_f32 v[112:113], v[96:97], v[118:119], v[112:113] neg_lo:[0,0,1] neg_hi:[0,0,1]
    v_pk_fma_f32 v[114:115], v[98:99], v[118:119], v[114:115] neg_lo:[0,0,1] neg_hi:[0,0,1]
    v_cvt_pk_bf16_f32 v16, v100, v101
    v_cvt_pk_bf16_f32 v17, v102, v103
    v_cvt_pk_bf16_f32 v18, v104, v105
    v_cvt_pk_bf16_f32 v19, v106, v107
    v_cvt_pk_bf16_f32 v56, v108, v109
    v_cvt_pk_bf16_f32 v57, v110, v111
    v_cvt_pk_bf16_f32 v58, v112, v113
    v_cvt_pk_bf16_f32 v59, v114, v115
    v_pk_fma_f32 v[84:85], v[100:101], v[118:119], v[84:85] neg_lo:[0,0,1] neg_hi:[0,0,1]
    v_pk_fma_f32 v[86:87], v[102:103], v[118:119], v[86:87] neg_lo:[0,0,1] neg_hi:[0,0,1]
    v_pk_fma_f32 v[88:89], v[104:105], v[118:119], v[88:89] neg_lo:[0,0,1] neg_hi:[0,0,1]
    v_pk_fma_f32 v[90:91], v[106:107], v[118:119], v[90:91] neg_lo:[0,0,1] neg_hi:[0,0,1]
    v_pk_fma_f32 v[92:93], v[108:109], v[118:119], v[92:93] neg_lo:[0,0,1] neg_hi:[0,0,1]
    v_pk_fma_f32 v[94:95], v[110:111], v[118:119], v[94:95] neg_lo:[0,0,1] neg_hi:[0,0,1]
    v_pk_fma_f32 v[96:97], v[112:113], v[118:119], v[96:97] neg_lo:[0,0,1] neg_hi:[0,0,1]
    v_pk_fma_f32 v[98:99], v[114:115], v[118:119], v[98:99] neg_lo:[0,0,1] neg_hi:[0,0,1]
    v_cvt_pk_bf16_f32 v20, v84, v85
    v_cvt_pk_bf16_f32 v21, v86, v87
    v_cvt_pk_bf16_f32 v22, v88, v89
    v_cvt_pk_bf16_f32 v23, v90, v91
    v_cvt_pk_bf16_f32 v60, v92, v93
    v_cvt_pk_bf16_f32 v61, v94, v95
    v_cvt_pk_bf16_f32 v62, v96, v97
    v_cvt_pk_bf16_f32 v63, v98, v99
    v_pk_fma_f32 v[100:101], v[84:85], v[118:119], v[100:101] neg_lo:[0,0,1] neg_hi:[0,0,1]
    v_pk_fma_f32 v[102:103], v[86:87], v[118:119], v[102:103] neg_lo:[0,0,1] neg_hi:[0,0,1]
    v_pk_fma_f32 v[104:105], v[88:89], v[118:119], v[104:105] neg_lo:[0,0,1] neg_hi:[0,0,1]
    v_pk_fma_f32 v[106:107], v[90:91], v[118:119], v[106:107] neg_lo:[0,0,1] neg_hi:[0,0,1]
    v_pk_fma_f32 v[108:109], v[92:93], v[118:119], v[108:109] neg_lo:[0,0,1] neg_hi:[0,0,1]
    v_pk_fma_f32 v[110:111], v[94:95], v[118:119], v[110:111] neg_lo:[0,0,1] neg_hi:[0,0,1]
    v_pk_fma_f32 v[112:113], v[96:97], v[118:119], v[112:113] neg_lo:[0,0,1] neg_hi:[0,0,1]
    v_pk_fma_f32 v[114:115], v[98:99], v[118:119], v[114:115] neg_lo:[0,0,1] neg_hi:[0,0,1]
    v_cvt_pk_bf16_f32 v24, v100, v101
    v_cvt_pk_bf16_f32 v25, v102, v103
    v_cvt_pk_bf16_f32 v26, v104, v105
    v_cvt_pk_bf16_f32 v27, v106, v107
    v_cvt_pk_bf16_f32 v64, v108, v109
    v_cvt_pk_bf16_f32 v65, v110, v111
    v_cvt_pk_bf16_f32 v66, v112, v113
    v_cvt_pk_bf16_f32 v67, v114, v115
    s_waitcnt lgkmcnt(0)
    s_load_dword s44, s[40:41], 0
    s_mov_b32 s60, s40
    s_mov_b32 s61, s41
    v_pk_fma_f32 v[84:85], v[100:101], v[118:119], v[84:85] neg_lo:[0,0,1] neg_hi:[0,0,1]
    v_pk_fma_f32 v[86:87], v[102:103], v[118:119], v[86:87] neg_lo:[0,0,1] neg_hi:[0,0,1]
    v_pk_fma_f32 v[88:89], v[104:105], v[118:119], v[88:89] neg_lo:[0,0,1] neg_hi:[0,0,1]
    v_pk_fma_f32 v[90:91], v[106:107], v[118:119], v[90:91] neg_lo:[0,0,1] neg_hi:[0,0,1]
    v_pk_fma_f32 v[92:93], v[108:109], v[118:119], v[92:93] neg_lo:[0,0,1] neg_hi:[0,0,1]
    v_pk_fma_f32 v[94:95], v[110:111], v[118:119], v[94:95] neg_lo:[0,0,1] neg_hi:[0,0,1]
    v_pk_fma_f32 v[96:97], v[112:113], v[118:119], v[96:97] neg_lo:[0,0,1] neg_hi:[0,0,1]
    v_pk_fma_f32 v[98:99], v[114:115], v[118:119], v[98:99] neg_lo:[0,0,1] neg_hi:[0,0,1]
    v_cvt_pk_bf16_f32 v28, v84, v85
    v_cvt_pk_bf16_f32 v29, v86, v87
    v_cvt_pk_bf16_f32 v30, v88, v89
    v_cvt_pk_bf16_f32 v31, v90, v91
    v_cvt_pk_bf16_f32 v68, v92, v93
    v_cvt_pk_bf16_f32 v69, v94, v95
    v_cvt_pk_bf16_f32 v70, v96, v97
    v_cvt_pk_bf16_f32 v71, v98, v99
    v_pk_fma_f32 v[100:101], v[84:85], v[118:119], v[100:101] neg_lo:[0,0,1] neg_hi:[0,0,1]
    v_pk_fma_f32 v[102:103], v[86:87], v[118:119], v[102:103] neg_lo:[0,0,1] neg_hi:[0,0,1]
    v_pk_fma_f32 v[104:105], v[88:89], v[118:119], v[104:105] neg_lo:[0,0,1] neg_hi:[0,0,1]
    v_pk_fma_f32 v[106:107], v[90:91], v[118:119], v[106:107] neg_lo:[0,0,1] neg_hi:[0,0,1]
    v_pk_fma_f32 v[108:109], v[92:93], v[118:119], v[108:109] neg_lo:[0,0,1] neg_hi:[0,0,1]
    v_pk_fma_f32 v[110:111], v[94:95], v[118:119], v[110:111] neg_lo:[0,0,1] neg_hi:[0,0,1]
    v_pk_fma_f32 v[112:113], v[96:97], v[118:119], v[112:113] neg_lo:[0,0,1] neg_hi:[0,0,1]
    v_pk_fma_f32 v[114:115], v[98:99], v[118:119], v[114:115] neg_lo:[0,0,1] neg_hi:[0,0,1]
    v_cvt_pk_bf16_f32 v32, v100, v101
    v_cvt_pk_bf16_f32 v33, v102, v103
    v_cvt_pk_bf16_f32 v34, v104, v105
    v_cvt_pk_bf16_f32 v35, v106, v107
    v_cvt_pk_bf16_f32 v72, v108, v109
    v_cvt_pk_bf16_f32 v73, v110, v111
    v_cvt_pk_bf16_f32 v74, v112, v113
    v_cvt_pk_bf16_f32 v75, v114, v115
    v_pk_fma_f32 v[84:85], v[100:101], v[118:119], v[84:85] neg_lo:[0,0,1] neg_hi:[0,0,1]
    v_pk_fma_f32 v[86:87], v[102:103], v[118:119], v[86:87] neg_lo:[0,0,1] neg_hi:[0,0,1]
    v_pk_fma_f32 v[88:89], v[104:105], v[118:119], v[88:89] neg_lo:[0,0,1] neg_hi:[0,0,1]
    v_pk_fma_f32 v[90:91], v[106:107], v[118:119], v[90:91] neg_lo:[0,0,1] neg_hi:[0,0,1]
    v_pk_fma_f32 v[92:93], v[108:109], v[118:119], v[92:93] neg_lo:[0,0,1] neg_hi:[0,0,1]
    v_pk_fma_f32 v[94:95], v[110:111], v[118:119], v[94:95] neg_lo:[0,0,1] neg_hi:[0,0,1]
    v_pk_fma_f32 v[96:97], v[112:113], v[118:119], v[96:97] neg_lo:[0,0,1] neg_hi:[0,0,1]
    v_pk_fma_f32 v[98:99], v[114:115], v[118:119], v[98:99] neg_lo:[0,0,1] neg_hi:[0,0,1]
    v_cvt_pk_bf16_f32 v36, v84, v85
    v_cvt_pk_bf16_f32 v37, v86, v87
    v_cvt_pk_bf16_f32 v38, v88, v89
    v_cvt_pk_bf16_f32 v39, v90, v91
    v_cvt_pk_bf16_f32 v76, v92, v93
    v_cvt_pk_bf16_f32 v77, v94, v95
    v_cvt_pk_bf16_f32 v78, v96, v97
    v_cvt_pk_bf16_f32 v79, v98, v99
    v_pk_fma_f32 v[100:101], v[84:85], v[118:119], v[100:101] neg_lo:[0,0,1] neg_hi:[0,0,1]
    v_pk_fma_f32 v[102:103], v[86:87], v[118:119], v[102:103] neg_lo:[0,0,1] neg_hi:[0,0,1]
    v_pk_fma_f32 v[104:105], v[88:89], v[118:119], v[104:105] neg_lo:[0,0,1] neg_hi:[0,0,1]
    v_pk_fma_f32 v[106:107], v[90:91], v[118:119], v[106:107] neg_lo:[0,0,1] neg_hi:[0,0,1]
    v_pk_fma_f32 v[108:109], v[92:93], v[118:119], v[108:109] neg_lo:[0,0,1] neg_hi:[0,0,1]
    v_pk_fma_f32 v[110:111], v[94:95], v[118:119], v[110:111] neg_lo:[0,0,1] neg_hi:[0,0,1]
    v_pk_fma_f32 v[112:113], v[96:97], v[118:119], v[112:113] neg_lo:[0,0,1] neg_hi:[0,0,1]
    v_pk_fma_f32 v[114:115], v[98:99], v[118:119], v[114:115] neg_lo:[0,0,1] neg_hi:[0,0,1]
    v_cvt_pk_bf16_f32 v40, v100, v101
    v_cvt_pk_bf16_f32 v41, v102, v103
    v_cvt_pk_bf16_f32 v42, v104, v105
    v_cvt_pk_bf16_f32 v43, v106, v107
    v_cvt_pk_bf16_f32 v80, v108, v109
    v_cvt_pk_bf16_f32 v81, v110, v111
    v_cvt_pk_bf16_f32 v82, v112, v113
    v_cvt_pk_bf16_f32 v83, v114, v115
    s_sub_u32 s54, 32, s47
    s_min_u32 s54, s54, s47
    s_and_b32 s54, s54, 15
    s_cmp_ge_u32 s47, 16
    s_cselect_b32 s77, 16, 0
    s_xor_b32 s78, s77, 16
    s_cmp_eq_u32 s54, 0
    s_cselect_b32 s78, s77, s78
    s_mov_b32 s70, 0xbf80
    s_cmp_eq_u32 s49, 0
    s_cselect_b32 s70, 0x3f80, s70
    s_cselect_b32 s72, -1, 0
    s_cselect_b32 s74, 0, -1
    s_mov_b32 s73, 0
    s_mov_b32 s75, 0
    v_and_b32 v0, 1, v0
    v_lshlrev_b32 v0, 15, v0
    v_xor_b32 v0, s70, v0
    v_bfi_b32 v116, s57, v44, v0
    v_cndmask_b32 v44, v44, v116, s[74:75]
    v_cndmask_b32 v0, 0, v0, s[72:73]
    v_lshrrev_b32 v116, 1, v2
    v_and_b32 v117, 1, v2
    v_mul_u32_u24 v116, 114688, v116
    v_lshl_add_u32 v116, v117, 4, v116
    v_mul_u32_u24 v2, 656, v2
    v_lshl_add_u32 v2, v3, 4, v2
    v_lshl_add_u32 v3, v3, 5, v116
    s_lshl_b32 s71, s50, 10
    s_add_u32 s71, s71, s46
    s_mul_i32 s71, s71, 1792
    s_lshl_b32 s72, s49, 6
    s_add_u32 s71, s71, s72
    s_lshr_b32 s72, s68, 1
    s_mul_i32 s72, s72, 896
    s_add_u32 s71, s71, s72
    s_and_b32 s72, s68, 1
    s_lshl_b32 s73, s72, 9
    s_add_u32 s71, s71, s73
    s_add_u32 s71, s71, 1310720
    s_mov_b32 s27, 1
    s_waitcnt vmcnt(0) lgkmcnt(0)
    s_add_u32 s44, s44, 2654435769
    v_lshlrev_b32 v1, 4, v1
    s_barrier
    s_setprio 3
    ds_read_b128 v[100:103], v2 offset:0
    ds_read_b128 v[104:107], v2 offset:32
    ds_read_b128 v[108:111], v2 offset:64
    ds_read_b128 v[112:115], v2 offset:96
    ds_read_b128 v[116:119], v2 offset:128
    ds_read_b128 v[120:123], v2 offset:160
    ds_read_b128 v[124:127], v2 offset:192
    s_waitcnt lgkmcnt(6)
    v_mfma_f32_32x32x16_bf16 v[84:99], v[100:103], v[4:7], 0
    ds_read_b128 v[100:103], v2 offset:224
    s_waitcnt lgkmcnt(6)
    v_mfma_f32_32x32x16_bf16 v[84:99], v[104:107], v[8:11], v[84:99]
    ds_read_b128 v[104:107], v2 offset:256
    s_waitcnt lgkmcnt(6)
    v_mfma_f32_32x32x16_bf16 v[84:99], v[108:111], v[12:15], v[84:99]
    ds_read_b128 v[108:111], v2 offset:288
    s_waitcnt lgkmcnt(6)
    v_mfma_f32_32x32x16_bf16 v[84:99], v[112:115], v[16:19], v[84:99]
    ds_read_b128 v[112:115], v2 offset:320
    s_waitcnt lgkmcnt(6)
    v_mfma_f32_32x32x16_bf16 v[84:99], v[116:119], v[20:23], v[84:99]
    ds_read_b128 v[116:119], v2 offset:352
    s_waitcnt lgkmcnt(6)
    v_mfma_f32_32x32x16_bf16 v[84:99], v[120:123], v[24:27], v[84:99]
    ds_read_b128 v[120:123], v2 offset:384
    s_waitcnt lgkmcnt(6)
    v_mfma_f32_32x32x16_bf16 v[84:99], v[124:127], v[28:31], v[84:99]
    ds_read_b128 v[124:127], v2 offset:416
    v_mov_b32 v20, v0
    v_mov_b32 v21, 0
    v_mov_b32 v22, 0
    v_mov_b32 v23, 0
    s_waitcnt lgkmcnt(6)
    v_mfma_f32_32x32x16_bf16 v[84:99], v[100:103], v[32:35], v[84:99]
    ds_read_b128 v[100:103], v2 offset:448
    s_waitcnt lgkmcnt(6)
    v_mfma_f32_32x32x16_bf16 v[84:99], v[104:107], v[36:39], v[84:99]
    ds_read_b128 v[104:107], v2 offset:480
    s_waitcnt lgkmcnt(6)
    v_mfma_f32_32x32x16_bf16 v[84:99], v[108:111], v[40:43], v[84:99]
    ds_read_b128 v[108:111], v2 offset:512
    s_waitcnt lgkmcnt(6)
    v_mfma_f32_32x32x16_bf16 v[84:99], v[112:115], v[20:23], v[84:99]
    v_mfma_f32_32x32x16_bf16 v[4:19], v[112:115], v[44:47], 0
    ds_read_b128 v[112:115], v2 offset:544
    ds_read_b128 v[24:27], v1 offset:20992
    ds_read_b128 v[28:31], v1 offset:22016
    s_waitcnt lgkmcnt(8)
    v_mfma_f32_32x32x16_bf16 v[4:19], v[116:119], v[48:51], v[4:19]
    ds_read_b128 v[116:119], v2 offset:576
    ds_read_b128 v[32:35], v1 offset:23040
    ds_read_b128 v[36:39], v1 offset:24064
    s_waitcnt lgkmcnt(10)
    v_mfma_f32_32x32x16_bf16 v[4:19], v[120:123], v[52:55], v[4:19]
    ds_read_b128 v[120:123], v2 offset:608
    ds_read_b128 v[40:43], v1 offset:25088
    v_mov_b32 v0, 1
    ds_write_b32 v21, v0 offset:60192
    s_waitcnt lgkmcnt(12)
    v_mfma_f32_32x32x16_bf16 v[4:19], v[124:127], v[56:59], v[4:19]
    ds_read_b128 v[44:47], v1 offset:26112
    v_cvt_pk_bf16_f32 v84, v84, v85
    v_cvt_pk_bf16_f32 v85, v86, v87
    s_waitcnt lgkmcnt(12)
    v_mfma_f32_32x32x16_bf16 v[4:19], v[100:103], v[60:63], v[4:19]
    ds_read_b128 v[48:51], v1 offset:27136
    v_cvt_pk_bf16_f32 v86, v88, v89
    v_cvt_pk_bf16_f32 v87, v90, v91
    s_waitcnt lgkmcnt(12)
    v_mfma_f32_32x32x16_bf16 v[4:19], v[104:107], v[64:67], v[4:19]
    ds_read_b128 v[52:55], v1 offset:28160
    v_cvt_pk_bf16_f32 v88, v92, v93
    v_cvt_pk_bf16_f32 v89, v94, v95
    s_waitcnt lgkmcnt(12)
    v_mfma_f32_32x32x16_bf16 v[4:19], v[108:111], v[68:71], v[4:19]
    v_cvt_pk_bf16_f32 v90, v96, v97
    v_cvt_pk_bf16_f32 v91, v98, v99
    s_waitcnt lgkmcnt(11)
    v_mfma_f32_32x32x16_bf16 v[4:19], v[112:115], v[72:75], v[4:19]
    s_waitcnt lgkmcnt(8)
    v_mfma_f32_32x32x16_bf16 v[4:19], v[116:119], v[76:79], v[4:19]
    s_waitcnt lgkmcnt(5)
    v_mfma_f32_32x32x16_bf16 v[4:19], v[120:123], v[80:83], v[4:19]
    s_waitcnt lgkmcnt(0)
    v_mfma_f32_32x32x16_bf16 v[56:71], v[84:87], v[24:27], 0
    v_mfma_f32_32x32x16_bf16 v[100:115], v[84:87], v[32:35], 0
    v_mfma_f32_32x32x16_bf16 v[56:71], v[88:91], v[28:31], v[56:71]
    s_nop 7
    v_cvt_pk_bf16_f32 v4, v4, v5
    v_cvt_pk_bf16_f32 v5, v6, v7
    v_cvt_pk_bf16_f32 v6, v8, v9
    v_cvt_pk_bf16_f32 v7, v10, v11
    v_cvt_pk_bf16_f32 v8, v12, v13
    v_cvt_pk_bf16_f32 v9, v14, v15
    v_cvt_pk_bf16_f32 v10, v16, v17
    v_cvt_pk_bf16_f32 v11, v18, v19
    v_mfma_f32_32x32x16_bf16 v[100:115], v[88:91], v[36:39], v[100:115]
    v_mfma_f32_32x32x16_bf16 v[56:71], v[4:7], v[40:43], v[56:71]
    v_mfma_f32_32x32x16_bf16 v[100:115], v[4:7], v[48:51], v[100:115]
    v_mov_b32 v75, s44
    v_mov_b32 v79, s44
    v_mov_b32 v83, s44
    v_mov_b32 v95, s44
    v_mfma_f32_32x32x16_bf16 v[56:71], v[8:11], v[44:47], v[56:71]
    ds_read_b32 v0, v21 offset:60196
    v_mfma_f32_32x32x16_bf16 v[100:115], v[8:11], v[52:55], v[100:115]
    v_lshrrev_b32 v1, 4, v1
    v_mov_b32 v20, 1
    ds_write_b32 v21, v20 offset:60236
    s_nop 8
    v_cvt_pk_bf16_f32 v72, v56, v100
    v_cvt_pk_bf16_f32 v73, v57, v101
    v_cvt_pk_bf16_f32 v74, v58, v102
    v_cvt_pk_bf16_f32 v76, v60, v104
    v_cvt_pk_bf16_f32 v77, v61, v105
    v_cvt_pk_bf16_f32 v78, v62, v106
    v_cvt_pk_bf16_f32 v80, v64, v108
    v_cvt_pk_bf16_f32 v81, v65, v109
    v_cvt_pk_bf16_f32 v82, v66, v110
    v_cvt_pk_bf16_f32 v92, v68, v112
    v_cvt_pk_bf16_f32 v93, v69, v113
    v_cvt_pk_bf16_f32 v94, v70, v114
L_hold:
    s_waitcnt lgkmcnt(0)
    v_readfirstlane_b32 s73, v0
    s_nop 0
    s_cmp_lt_u32 s73, s27
    s_cbranch_scc1 L_hold2
L_hold3:
    buffer_store_dwordx4 v[72:75], v3, s[60:63], s71 offen offset:0 sc1
    buffer_store_dwordx4 v[76:79], v3, s[60:63], s71 offen offset:128 sc1
    buffer_store_dwordx4 v[80:83], v3, s[60:63], s71 offen offset:256 sc1
    s_cmp_lg_u32 s72, 0
    s_cbranch_scc1 L_st1
    buffer_store_dwordx4 v[92:95], v3, s[60:63], s71 offen offset:384 sc1
L_st1:
    s_branch L_hprep
L_w12:
    s_setprio 3
    v_and_b32 v72, 31, v1
    v_lshrrev_b32 v73, 5, v1
    v_lshrrev_b32 v74, 1, v72
    v_cmp_eq_u32 vcc, 1, v72
    s_nop 1
    v_cndmask_b32 v74, v74, 16, vcc
    s_mov_b32 s74, 0xaaaaaaa8
    s_mov_b32 s75, 0xaaaaaaa8
    v_mov_b32 v75, 0x80008000
    v_cndmask_b32 v76, 0, v75, s[74:75]
    v_xor_b32 v75, v75, v76
    v_cvt_f32_u32 v74, v74
    v_mul_f32 v74, 0x3d000000, v74
    v_lshlrev_b32 v77, 2, v73
    v_cvt_f32_u32 v77, v77
    v_mul_f32 v77, v77, v74
    v_lshlrev_b32 v78, 4, v1
    s_mov_b32 s73, 0
L_gk:
    v_cos_f32 v80, v77
    v_sin_f32 v84, v77
    v_add_f32 v77, v77, v74
    v_cos_f32 v81, v77
    v_sin_f32 v85, v77
    v_add_f32 v77, v77, v74
    v_cos_f32 v82, v77
    v_sin_f32 v86, v77
    v_add_f32 v77, v77, v74
    v_cos_f32 v83, v77
    v_sin_f32 v87, v77
    v_add_f32 v77, v77, v74
    v_fma_f32 v77, v74, 4.0, v77
    v_cvt_pk_bf16_f32 v112, v80, v81
    v_cvt_pk_bf16_f32 v113, v82, v83
    v_cvt_pk_bf16_f32 v114, v84, v85
    v_cvt_pk_bf16_f32 v115, v86, v87
    v_xor_b32 v116, v76, v114
    v_xor_b32 v117, v76, v115
    v_xor_b32 v118, v75, v112
    v_xor_b32 v119, v75, v113
    ds_write_b64 v78, v[112:113] offset:20992
    ds_write_b64 v78, v[114:115] offset:23040
    ds_write_b64 v78, v[116:117] offset:25088
    ds_write_b64 v78, v[118:119] offset:27136
    s_bitcmp1_b32 s73, 0
    s_cselect_b32 s74, 1016, 8
    v_add_u32 v78, s74, v78
    s_add_u32 s73, s73, 1
    s_cmp_lg_u32 s73, 4
    s_cbranch_scc1 L_gk
    v_lshlrev_b32 v72, 6, v72
    v_add_u32 v72, s46, v72
    v_cvt_f32_u32 v72, v72
    s_mov_b32 s73, 0xba000000
    s_cmp_gt_u32 s47, 16
    s_cselect_b32 s73, 0x3a000000, s73
    v_mul_f32 v72, s73, v72
    v_lshlrev_b32 v73, 2, v73
    v_cvt_f32_u32 v73, v73
    v_mul_f32 v73, v73, v72
    v_lshlrev_b32 v79, 4, v1
    s_mov_b32 s73, 0
    s_mov_b32 s68, 4
    s_waitcnt vmcnt(0) lgkmcnt(0)
    s_mov_b32 s60, s40
    s_mov_b32 s61, s41
    s_setprio 2
    s_barrier
L_kk:
    v_cos_f32 v80, v73
    v_sin_f32 v84, v73
    v_add_f32 v73, v73, v72
    v_cos_f32 v81, v73
    v_sin_f32 v85, v73
    v_add_f32 v73, v73, v72
    v_cos_f32 v82, v73
    v_sin_f32 v86, v73
    v_add_f32 v73, v73, v72
    v_cos_f32 v83, v73
    v_sin_f32 v87, v73
    v_add_f32 v73, v73, v72
    v_fma_f32 v73, v72, 4.0, v73
    v_cvt_pk_bf16_f32 v120, v80, v84
    v_cvt_pk_bf16_f32 v122, v81, v85
    v_cvt_pk_bf16_f32 v121, v82, v86
    v_cvt_pk_bf16_f32 v123, v83, v87
    ds_write_b128 v79, v[120:123] offset:29184
    v_cos_f32 v80, v73
    v_sin_f32 v84, v73
    v_add_f32 v73, v73, v72
    v_cos_f32 v81, v73
    v_sin_f32 v85, v73
    v_add_f32 v73, v73, v72
    v_cos_f32 v82, v73
    v_sin_f32 v86, v73
    v_add_f32 v73, v73, v72
    v_cos_f32 v83, v73
    v_sin_f32 v87, v73
    v_add_f32 v73, v73, v72
    v_fma_f32 v73, v72, 4.0, v73
    v_cvt_pk_bf16_f32 v88, v80, v84
    v_cvt_pk_bf16_f32 v90, v81, v85
    v_cvt_pk_bf16_f32 v89, v82, v86
    v_cvt_pk_bf16_f32 v91, v83, v87
    ds_write_b128 v79, v[88:91] offset:30208
    v_add_u32 v79, 2048, v79
    s_add_u32 s73, s73, 1
    s_cmp_lg_u32 s73, 4
    s_cbranch_scc1 L_kk
    v_mov_b32 v72, 0
    v_mov_b32 v73, 1
    ds_write_b32 v72, v73 offset:60232
    s_branch L_P2
L_hold2:
    s_sleep 1
    ds_read_b32 v0, v21 offset:60196
    s_sub_u32 s58, s58, 1
    s_cmp_lg_u32 s58, 0
    s_cbranch_scc1 L_hold
    s_branch L_hold3
L_roleFD:
    s_setprio 1
    s_lshl_b32 s64, s2, 1
    s_add_u32 s64, s64, s45
    s_sub_u32 s64, s64, 278
    s_add_u32 s65, s2, 135
    s_cmp_eq_u32 s45, 9
    s_cselect_b32 s65, s65, 0
    s_cmp_ge_u32 s65, 242
    s_cselect_b32 s65, s65, 400
    s_cmp_ge_u32 s2, 135
    s_cselect_b32 s54, s64, s65
    s_lshr_b32 s51, s54, 1
    s_sub_u32 s65, s2, 0
    s_min_u32 s65, s65, 200
    s_cmp_eq_u32 s45, 10
    s_cselect_b32 s51, s65, s51
    v_mov_b32 v0, 0
    s_mul_i32 s52, s51, 52429
    s_lshr_b32 s52, s52, 18
    s_mul_i32 s64, s52, 5
    s_sub_u32 s53, s51, s64
    s_mov_b32 s66, 0x05040100
    s_mov_b32 s67, 0x07060302
    s_mov_b32 s4, 0xffff0000
    s_mov_b32 s5, 0
    s_mov_b32 s6, 0
    s_mov_b32 s7, 0xffff
    s_mov_b32 s8, 0
    s_mov_b32 s9, 0xffff0000
    s_mov_b32 s15, 0x20000
    s_waitcnt lgkmcnt(0)
    s_load_dword s44, s[40:41], 0
    s_mov_b32 s60, s40
    s_mov_b32 s61, s41
    v_lshlrev_b32 v5, 4, v1
    s_waitcnt lgkmcnt(0)
    v_mov_b32 v121, s44
    v_mov_b32 v123, s44
    s_add_u32 s44, s44, 2654435769
    s_cmp_eq_u32 s45, 10
    s_cbranch_scc1 L_roleD
    s_cmp_ge_u32 s51, 135
    s_cbranch_scc1 L_bump
    s_bitcmp0_b32 s54, 0
    s_cselect_b32 s12, s30, s32
    s_cselect_b32 s13, s31, s33
    s_mov_b32 s14, 2211840
    s_mul_i32 s72, s53, 442368
    s_lshl_b32 s73, s52, 7
    s_add_u32 s72, s72, s73
    v_mul_u32_u24 v4, 27648, v3
    v_lshl_add_u32 v4, v2, 3, v4
    s_lshl_b32 s74, s54, 10
    s_add_u32 s74, s74, 294912
    s_add_u32 s75, s74, 276736
    buffer_store_dwordx4 v[120:123], v5, s[60:63], s74 offen sc1
    buffer_store_dwordx4 v[120:123], v5, s[60:63], s75 offen sc1
    buffer_load_dwordx2 v[24:25], v4, s[12:15], s72 offen nt
    s_add_u32 s72, s72, 3456
    buffer_load_dwordx2 v[26:27], v4, s[12:15], s72 offen nt
    s_add_u32 s72, s72, 3456
    buffer_load_dwordx2 v[28:29], v4, s[12:15], s72 offen nt
    s_add_u32 s72, s72, 3456
    buffer_load_dwordx2 v[30:31], v4, s[12:15], s72 offen nt
    s_add_u32 s72, s72, 3456
    buffer_load_dwordx2 v[32:33], v4, s[12:15], s72 offen nt
    s_add_u32 s72, s72, 3456
    buffer_load_dwordx2 v[34:35], v4, s[12:15], s72 offen nt
    s_add_u32 s72, s72, 3456
    buffer_load_dwordx2 v[36:37], v4, s[12:15], s72 offen nt
    s_add_u32 s72, s72, 3456
    buffer_load_dwordx2 v[38:39], v4, s[12:15], s72 offen nt
    s_add_u32 s72, s72, 86400
    buffer_load_dwordx2 v[40:41], v4, s[12:15], s72 offen nt
    s_add_u32 s72, s72, 3456
    buffer_load_dwordx2 v[42:43], v4, s[12:15], s72 offen nt
    s_add_u32 s72, s72, 3456
    buffer_load_dwordx2 v[44:45], v4, s[12:15], s72 offen nt
    s_add_u32 s72, s72, 3456
    buffer_load_dwordx2 v[46:47], v4, s[12:15], s72 offen nt
    s_add_u32 s72, s72, 3456
    buffer_load_dwordx2 v[48:49], v4, s[12:15], s72 offen nt
    s_add_u32 s72, s72, 3456
    buffer_load_dwordx2 v[50:51], v4, s[12:15], s72 offen nt
    s_add_u32 s72, s72, 3456
    buffer_load_dwordx2 v[52:53], v4, s[12:15], s72 offen nt
    s_add_u32 s72, s72, 3456
    buffer_load_dwordx2 v[54:55], v4, s[12:15], s72 offen nt
    s_add_u32 s72, s72, 86400
    buffer_load_dwordx2 v[56:57], v4, s[12:15], s72 offen nt
    s_add_u32 s72, s72, 3456
    buffer_load_dwordx2 v[58:59], v4, s[12:15], s72 offen nt
    s_add_u32 s72, s72, 3456
    buffer_load_dwordx2 v[60:61], v4, s[12:15], s72 offen nt
    s_add_u32 s72, s72, 3456
    buffer_load_dwordx2 v[62:63], v4, s[12:15], s72 offen nt
    s_add_u32 s72, s72, 3456
    buffer_load_dwordx2 v[64:65], v4, s[12:15], s72 offen nt
    s_add_u32 s72, s72, 3456
    buffer_load_dwordx2 v[66:67], v4, s[12:15], s72 offen nt
    s_add_u32 s72, s72, 3456
    buffer_load_dwordx2 v[68:69], v4, s[12:15], s72 offen nt
    s_add_u32 s72, s72, 3456
    buffer_load_dwordx2 v[70:71], v4, s[12:15], s72 offen nt
    s_add_u32 s72, s72, 86400
    buffer_load_dwordx2 v[72:73], v4, s[12:15], s72 offen nt
    s_add_u32 s72, s72, 3456
    buffer_load_dwordx2 v[74:75], v4, s[12:15], s72 offen nt
    s_add_u32 s72, s72, 3456
    buffer_load_dwordx2 v[76:77], v4, s[12:15], s72 offen nt
    s_add_u32 s72, s72, 3456
    buffer_load_dwordx2 v[78:79], v4, s[12:15], s72 offen nt
    s_add_u32 s72, s72, 3456
    buffer_load_dwordx2 v[80:81], v4, s[12:15], s72 offen nt
    s_add_u32 s72, s72, 3456
    buffer_load_dwordx2 v[82:83], v4, s[12:15], s72 offen nt
    s_add_u32 s72, s72, 3456
    buffer_load_dwordx2 v[84:85], v4, s[12:15], s72 offen nt
    s_add_u32 s72, s72, 3456
    buffer_load_dwordx2 v[86:87], v4, s[12:15], s72 offen nt
    s_add_u32 s72, s72, 86400
    s_barrier
    v_mov_b32 v88, s55
    v_mov_b32 v89, s55
    v_mov_b32 v90, s55
    v_mov_b32 v91, s55
    v_mov_b32 v92, s55
    v_mov_b32 v93, s55
    v_mov_b32 v94, s55
    v_mov_b32 v95, s55
    v_mov_b32 v96, s55
    v_mov_b32 v97, s55
    v_mov_b32 v98, s55
    v_mov_b32 v99, s55
    v_mov_b32 v100, s55
    v_mov_b32 v101, s55
    v_mov_b32 v102, s55
    v_mov_b32 v103, s55
    v_lshlrev_b32 v5, 6, v2
    v_lshl_add_u32 v5, v3, 4, v5
    s_lshl_b32 s76, s53, 8
    v_lshl_add_u32 v6, v3, 4, s76
    v_and_b32 v7, 1, v1
    s_movk_i32 s76, 1280
    v_mad_u32_u24 v6, v7, s76, v6
    v_mov_b32 v123, s44
    s_waitcnt vmcnt(24)
    v_perm_b32 v8, v26, v24, s66
    v_perm_b32 v9, v30, v28, s66
    v_perm_b32 v10, v34, v32, s66
    v_perm_b32 v11, v38, v36, s66
    v_perm_b32 v12, v26, v24, s67
    v_perm_b32 v13, v30, v28, s67
    v_perm_b32 v14, v34, v32, s67
    v_perm_b32 v15, v38, v36, s67
    v_perm_b32 v16, v27, v25, s66
    v_perm_b32 v17, v31, v29, s66
    v_perm_b32 v18, v35, v33, s66
    v_perm_b32 v19, v39, v37, s66
    v_perm_b32 v20, v27, v25, s67
    v_perm_b32 v21, v31, v29, s67
    v_perm_b32 v22, v35, v33, s67
    v_perm_b32 v23, v39, v37, s67
    s_waitcnt vmcnt(16)
    v_perm_b32 v24, v42, v40, s66
    v_perm_b32 v25, v46, v44, s66
    v_perm_b32 v26, v50, v48, s66
    v_perm_b32 v27, v54, v52, s66
    v_perm_b32 v28, v42, v40, s67
    v_perm_b32 v29, v46, v44, s67
    v_perm_b32 v30, v50, v48, s67
    v_perm_b32 v31, v54, v52, s67
    v_perm_b32 v32, v43, v41, s66
    v_perm_b32 v33, v47, v45, s66
    v_perm_b32 v34, v51, v49, s66
    v_perm_b32 v35, v55, v53, s66
    v_perm_b32 v36, v43, v41, s67
    v_perm_b32 v37, v47, v45, s67
    v_perm_b32 v38, v51, v49, s67
    v_perm_b32 v39, v55, v53, s67
    s_waitcnt vmcnt(8)
    v_perm_b32 v40, v58, v56, s66
    v_perm_b32 v41, v62, v60, s66
    v_perm_b32 v42, v66, v64, s66
    v_perm_b32 v43, v70, v68, s66
    v_perm_b32 v44, v58, v56, s67
    v_perm_b32 v45, v62, v60, s67
    v_perm_b32 v46, v66, v64, s67
    v_perm_b32 v47, v70, v68, s67
    v_perm_b32 v48, v59, v57, s66
    v_perm_b32 v49, v63, v61, s66
    v_perm_b32 v50, v67, v65, s66
    v_perm_b32 v51, v71, v69, s66
    v_perm_b32 v52, v59, v57, s67
    v_perm_b32 v53, v63, v61, s67
    v_perm_b32 v54, v67, v65, s67
    v_perm_b32 v55, v71, v69, s67
    s_waitcnt vmcnt(0)
    v_perm_b32 v56, v74, v72, s66
    v_perm_b32 v57, v78, v76, s66
    v_perm_b32 v58, v82, v80, s66
    v_perm_b32 v59, v86, v84, s66
    v_perm_b32 v60, v74, v72, s67
    v_perm_b32 v61, v78, v76, s67
    v_perm_b32 v62, v82, v80, s67
    v_perm_b32 v63, v86, v84, s67
    v_perm_b32 v64, v75, v73, s66
    v_perm_b32 v65, v79, v77, s66
    v_perm_b32 v66, v83, v81, s66
    v_perm_b32 v67, v87, v85, s66
    v_perm_b32 v68, v75, v73, s67
    v_perm_b32 v69, v79, v77, s67
    v_perm_b32 v70, v83, v81, s67
    v_perm_b32 v71, v87, v85, s67
    s_setprio 3
L_F_wait:
    ds_read_b32 v124, v0 offset:60200
    s_mov_b32 exec_lo, 0x33333333
    s_mov_b32 exec_hi, 0x33333333
    ds_read_b128 v[88:91], v6 offset:60512
    ds_read_b128 v[92:95], v6 offset:60576
    ds_read_b128 v[96:99], v6 offset:60640
    ds_read_b128 v[100:103], v6 offset:60704
    s_mov_b64 exec, -1
    s_waitcnt lgkmcnt(0)
    v_readfirstlane_b32 s68, v124
    s_nop 0
    s_cmp_lg_u32 s68, 0
    s_cbranch_scc1 L_F_go
    s_sleep 0
    s_sub_u32 s58, s58, 1
    s_cmp_lg_u32 s58, 0
    s_cbranch_scc1 L_F_wait
L_F_go:
    v_mfma_f32_16x16x32_bf16 v[104:107], v[88:91], v[8:11], 0
    v_mfma_f32_16x16x32_bf16 v[108:111], v[88:91], v[12:15], 0
    v_mfma_f32_16x16x32_bf16 v[112:115], v[88:91], v[16:19], 0
    v_mfma_f32_16x16x32_bf16 v[116:119], v[88:91], v[20:23], 0
    v_mfma_f32_16x16x32_bf16 v[104:107], v[92:95], v[24:27], v[104:107]
    v_mfma_f32_16x16x32_bf16 v[108:111], v[92:95], v[28:31], v[108:111]
    v_mfma_f32_16x16x32_bf16 v[112:115], v[92:95], v[32:35], v[112:115]
    v_mfma_f32_16x16x32_bf16 v[116:119], v[92:95], v[36:39], v[116:119]
    v_mfma_f32_16x16x32_bf16 v[104:107], v[96:99], v[40:43], v[104:107]
    v_mfma_f32_16x16x32_bf16 v[108:111], v[96:99], v[44:47], v[108:111]
    v_mfma_f32_16x16x32_bf16 v[112:115], v[96:99], v[48:51], v[112:115]
    v_mfma_f32_16x16x32_bf16 v[116:119], v[96:99], v[52:55], v[116:119]
    v_mfma_f32_16x16x32_bf16 v[104:107], v[100:103], v[56:59], v[104:107]
    v_mfma_f32_16x16x32_bf16 v[108:111], v[100:103], v[60:63], v[108:111]
    v_mfma_f32_16x16x32_bf16 v[112:115], v[100:103], v[64:67], v[112:115]
    v_mfma_f32_16x16x32_bf16 v[116:119], v[100:103], v[68:71], v[116:119]
    s_nop 5
    v_cndmask_b32 v120, v104, v108, s[4:5]
    v_cndmask_b32 v120, v120, v112, s[6:7]
    v_cndmask_b32 v120, v120, v116, s[8:9]
    v_cndmask_b32 v121, v105, v109, s[4:5]
    v_cndmask_b32 v121, v121, v113, s[6:7]
    v_cndmask_b32 v121, v121, v117, s[8:9]
    v_cndmask_b32 v122, v106, v110, s[4:5]
    v_cndmask_b32 v122, v122, v114, s[6:7]
    v_cndmask_b32 v122, v122, v118, s[8:9]
    buffer_store_dwordx4 v[120:123], v5, s[60:63], s74 offen sc1
    buffer_store_dwordx4 v[120:123], v5, s[60:63], s75 offen sc1
    s_waitcnt vmcnt(0)
    v_mov_b32 v104, 1
    s_mov_b64 exec, 1
    ds_add_u32 v0, v104 offset:60204
    s_mov_b64 exec, -1
    s_cmp_eq_u32 s45, 8
    s_cbranch_scc1 L_hprep
    s_endpgm
L_roleD:
    v_mov_b32 v112, 0
    v_mov_b32 v113, 0
    v_mov_b32 v114, 0
    v_mov_b32 v115, 0
    ds_write_b128 v0, v[112:115] offset:60192
    v_mov_b32 v113, 0
    ds_write_b128 v0, v[112:115] offset:60208
    ds_write_b128 v0, v[112:115] offset:60224
    s_cmp_ge_u32 s51, 135
    s_cbranch_scc1 L_Z_nfd
    s_mov_b32 s12, s34
    s_mov_b32 s13, s35
    s_mov_b32 s14, 2211840
    s_mul_i32 s72, s52, 81920
    s_lshl_b32 s74, s53, 8
    s_add_u32 s72, s72, s74
    v_mul_u32_u24 v4, 10240, v3
    v_lshl_add_u32 v4, v2, 3, v4
    s_mul_i32 s18, s53, 27
    s_add_u32 s18, s18, s52
    s_lshl_b32 s18, s18, 10
    s_add_u32 s18, s18, 851968
    s_add_u32 s19, s18, 138496
    s_mov_b32 s10, 0x03020105
    s_mov_b32 s11, 0x03020106
    s_mov_b32 s35, 0x03020107
    s_mul_i32 s28, s52, 10240
    s_add_u32 s28, s28, 294912
    s_add_u32 s29, s28, 4096
    s_add_u32 s30, s28, 8192
    buffer_load_dwordx2 v[24:25], v4, s[12:15], s72 offen offset:0 nt
    buffer_load_dwordx2 v[26:27], v4, s[12:15], s72 offen offset:1280 nt
    buffer_load_dwordx2 v[40:41], v4, s[12:15], s72 offen offset:128 nt
    buffer_load_dwordx2 v[42:43], v4, s[12:15], s72 offen offset:1408 nt
    s_add_u32 s72, s72, 2560
    buffer_load_dwordx2 v[28:29], v4, s[12:15], s72 offen offset:0 nt
    buffer_load_dwordx2 v[30:31], v4, s[12:15], s72 offen offset:1280 nt
    buffer_load_dwordx2 v[44:45], v4, s[12:15], s72 offen offset:128 nt
    buffer_load_dwordx2 v[46:47], v4, s[12:15], s72 offen offset:1408 nt
    s_add_u32 s72, s72, 2560
    buffer_load_dwordx2 v[32:33], v4, s[12:15], s72 offen offset:0 nt
    buffer_load_dwordx2 v[34:35], v4, s[12:15], s72 offen offset:1280 nt
    buffer_load_dwordx2 v[48:49], v4, s[12:15], s72 offen offset:128 nt
    buffer_load_dwordx2 v[50:51], v4, s[12:15], s72 offen offset:1408 nt
    s_add_u32 s72, s72, 2560
    buffer_load_dwordx2 v[36:37], v4, s[12:15], s72 offen offset:0 nt
    buffer_load_dwordx2 v[38:39], v4, s[12:15], s72 offen offset:1280 nt
    buffer_load_dwordx2 v[52:53], v4, s[12:15], s72 offen offset:128 nt
    buffer_load_dwordx2 v[54:55], v4, s[12:15], s72 offen offset:1408 nt
    s_add_u32 s72, s72, 33280
    buffer_load_dwordx2 v[56:57], v4, s[12:15], s72 offen offset:0 nt
    buffer_load_dwordx2 v[58:59], v4, s[12:15], s72 offen offset:1280 nt
    buffer_load_dwordx2 v[72:73], v4, s[12:15], s72 offen offset:128 nt
    buffer_load_dwordx2 v[74:75], v4, s[12:15], s72 offen offset:1408 nt
    s_add_u32 s72, s72, 2560
    buffer_load_dwordx2 v[60:61], v4, s[12:15], s72 offen offset:0 nt
    buffer_load_dwordx2 v[62:63], v4, s[12:15], s72 offen offset:1280 nt
    buffer_load_dwordx2 v[76:77], v4, s[12:15], s72 offen offset:128 nt
    buffer_load_dwordx2 v[78:79], v4, s[12:15], s72 offen offset:1408 nt
    s_add_u32 s72, s72, 2560
    buffer_load_dwordx2 v[64:65], v4, s[12:15], s72 offen offset:0 nt
    buffer_load_dwordx2 v[66:67], v4, s[12:15], s72 offen offset:1280 nt
    buffer_load_dwordx2 v[80:81], v4, s[12:15], s72 offen offset:128 nt
    buffer_load_dwordx2 v[82:83], v4, s[12:15], s72 offen offset:1408 nt
    s_add_u32 s72, s72, 2560
    buffer_load_dwordx2 v[68:69], v4, s[12:15], s72 offen offset:0 nt
    buffer_load_dwordx2 v[70:71], v4, s[12:15], s72 offen offset:1280 nt
    buffer_load_dwordx2 v[84:85], v4, s[12:15], s72 offen offset:128 nt
    buffer_load_dwordx2 v[86:87], v4, s[12:15], s72 offen offset:1408 nt
    s_add_u32 s72, s72, 33280
L_Z_nfd:
    s_waitcnt lgkmcnt(0)
L_Z_0:
    s_setprio 3
    s_and_b32 s64, s2, 7
    s_mul_i32 s64, s64, 2
    v_lshlrev_b32 v4, 4, v1
    v_and_b32 v110, 31, v1
    v_lshlrev_b32 v111, 3, v110
    v_lshlrev_b32 v110, 4, v110
    v_lshrrev_b32 v112, 5, v1
    v_mul_u32_u24 v112, 1280, v112
    v_add_u32 v113, v112, v111
    v_add_u32 v112, v112, v110
    v_mov_b32 v116, 0
    v_mov_b32 v118, 0
    v_mov_b32 v104, 1
    s_mov_b32 s70, 0
    s_mov_b32 s71, -1
    s_mov_b64 s[20:21], -1
    s_mov_b64 s[22:23], -1
    s_mov_b64 s[24:25], -1
    s_mov_b64 s[26:27], -1
    s_barrier
L_Z_w:
    ds_read_b32 v88, v0 offset:60192
    s_waitcnt lgkmcnt(0)
    v_readfirstlane_b32 s68, v88
    s_nop 0
    s_cmp_ge_u32 s68, 1
    s_cbranch_scc1 L_Z_w_ok
    s_sleep 1
    s_sub_u32 s58, s58, 1
    s_cmp_lg_u32 s58, 0
    s_cbranch_scc1 L_Z_w
L_Z_w_ok:
    s_mov_b32 s58, 2000000
    s_movk_i32 s68, 1280
    s_movk_i32 s69, 0x7ff
    v_mov_b32 v114, 58896
    s_mul_i32 s65, s64, 4352
    s_add_u32 s65, s65, 8192
    s_add_u32 s32, s65, 1024
    s_add_u32 s33, s65, 2048
    s_add_u32 s34, s65, 3072
    s_add_u32 s64, s64, 1
    s_and_b32 s64, s64, 15
    s_mov_b64 exec, s[20:21]
    s_cbranch_execz L_zza0
    buffer_load_dwordx4 v[88:91], v4, s[60:63], s65 offen sc1
L_zza0:
    s_mov_b64 exec, s[22:23]
    s_cbranch_execz L_zza1
    buffer_load_dwordx4 v[92:95], v4, s[60:63], s32 offen sc1
L_zza1:
    s_mov_b64 exec, s[24:25]
    s_cbranch_execz L_zza2
    buffer_load_dwordx4 v[96:99], v4, s[60:63], s33 offen sc1
L_zza2:
    s_mov_b64 exec, s[26:27]
    s_cbranch_execz L_zza3
    buffer_load_dwordx4 v[100:103], v4, s[60:63], s34 offen sc1
L_zza3:
    s_mov_b64 exec, -1
    s_waitcnt vmcnt(0)
L_Z_chk:
    v_cmp_ne_u32 s[20:21], s44, v91
    v_cmp_ne_u32 s[22:23], s44, v95
    v_cmp_ne_u32 s[24:25], s44, v99
    v_cmp_ne_u32 s[26:27], s44, v103
    s_or_b64 s[72:73], s[20:21], s[22:23]
    s_or_b64 vcc, s[24:25], s[26:27]
    s_or_b64 vcc, vcc, s[72:73]
    s_cbranch_scc1 L_Z_miss
L_Z_kd:
    v_min_u32 v105, v88, v92
    v_min_u32 v106, v96, v100
    v_max_u32 v88, v88, v92
    v_max_u32 v96, v96, v100
    v_max3_u32 v89, v89, v93, v105
    v_max3_u32 v97, v97, v101, v106
    v_max_u32 v105, v88, v96
    v_min_u32 v92, v88, v96
    v_max3_u32 v106, v89, v97, v92
    v_min_u32_dpp v107, v105, v105 row_ror:8 row_mask:0xf bank_mask:0xf
    s_nop 0
    v_max_u32_dpp v108, v106, v106 row_ror:8 row_mask:0xf bank_mask:0xf
    v_max_u32_dpp v105, v105, v105 row_ror:8 row_mask:0xf bank_mask:0xf
    v_max_u32 v106, v107, v108
    s_nop 0
    v_min_u32_dpp v107, v105, v105 row_ror:4 row_mask:0xf bank_mask:0xf
    v_max_u32_dpp v108, v106, v106 row_ror:4 row_mask:0xf bank_mask:0xf
    v_max_u32_dpp v105, v105, v105 row_ror:4 row_mask:0xf bank_mask:0xf
    v_max_u32 v106, v107, v108
    s_nop 0
    v_min_u32_dpp v107, v105, v105 row_ror:2 row_mask:0xf bank_mask:0xf
    v_max_u32_dpp v108, v106, v106 row_ror:2 row_mask:0xf bank_mask:0xf
    v_max_u32_dpp v105, v105, v105 row_ror:2 row_mask:0xf bank_mask:0xf
    v_max_u32 v106, v107, v108
    s_nop 0
    v_min_u32_dpp v107, v105, v105 row_ror:1 row_mask:0xf bank_mask:0xf
    v_max_u32_dpp v108, v106, v106 row_ror:1 row_mask:0xf bank_mask:0xf
    v_max_u32_dpp v105, v105, v105 row_ror:1 row_mask:0xf bank_mask:0xf
    v_max_u32 v106, v107, v108
    v_mov_b32 v108, v105
    v_mov_b32 v109, v106
    s_nop 0
    v_permlane16_swap_b32 v108, v105
    v_permlane16_swap_b32 v109, v106
    v_min_u32 v107, v108, v105
    v_max_u32 v105, v108, v105
    v_max3_u32 v106, v106, v109, v107
    v_mov_b32 v108, v105
    v_mov_b32 v109, v106
    s_nop 0
    v_permlane32_swap_b32 v108, v105
    v_permlane32_swap_b32 v109, v106
    v_min_u32 v107, v108, v105
    v_max_u32 v105, v108, v105
    v_max3_u32 v106, v106, v109, v107
    v_cndmask_b32 v107, v105, v106, s[70:71]
    v_bitop3_b32 v107, v107, v107, s69 bitop3:0x0a
    v_mad_u32_u24 v108, v107, s68, v110
    v_mad_u32_u24 v109, v107, s68, v111
    global_load_dwordx4 v[8:11], v108, s[16:17]
    global_load_dwordx4 v[12:15], v108, s[16:17] offset:512
    global_load_dwordx2 v[16:17], v109, s[16:17] offset:1024
    ds_write2_b32 v114, v105, v106 offset0:0 offset1:1
    ds_write_b32 v0, v104 offset:60196
    s_waitcnt vmcnt(0)
    ds_write_b128 v112, v[8:11] offset:60512
    ds_write_b128 v112, v[12:15] offset:61024
    ds_write_b64 v113, v[16:17] offset:61536
    ds_write_b32 v0, v104 offset:60200
    s_cmp_ge_u32 s51, 135
    s_cbranch_scc1 L_Z_xonly
    v_lshlrev_b32 v4, 4, v1
    v_lshlrev_b32 v6, 1, v1
    v_and_b32 v7, 1, v2
    v_lshlrev_b32 v7, 7, v7
    v_lshl_add_u32 v7, v3, 4, v7
    v_mov_b32 v123, s44
    v_and_b32 v107, 63, v107
    v_cmp_eq_u32 vcc, s46, v107
    s_nop 0
    s_or_b32 s36, vcc_lo, vcc_hi
    s_mov_b32 s58, 2000000
    v_dot2c_f32_bf16 v116, s55, v8
    v_dot2c_f32_bf16 v118, v8, v8
    v_dot2c_f32_bf16 v116, s55, v9
    v_dot2c_f32_bf16 v118, v9, v9
    v_dot2c_f32_bf16 v116, s55, v10
    v_dot2c_f32_bf16 v118, v10, v10
    v_dot2c_f32_bf16 v116, s55, v11
    v_dot2c_f32_bf16 v118, v11, v11
    v_dot2c_f32_bf16 v116, s55, v12
    v_dot2c_f32_bf16 v118, v12, v12
    v_dot2c_f32_bf16 v116, s55, v13
    v_dot2c_f32_bf16 v118, v13, v13
    v_dot2c_f32_bf16 v116, s55, v14
    v_dot2c_f32_bf16 v118, v14, v14
    v_dot2c_f32_bf16 v116, s55, v15
    v_dot2c_f32_bf16 v118, v15, v15
    v_dot2c_f32_bf16 v116, s55, v16
    v_dot2c_f32_bf16 v118, v16, v16
    v_dot2c_f32_bf16 v116, s55, v17
    v_dot2c_f32_bf16 v118, v17, v17
    s_nop 1
    v_add_f32_dpp v116, v116, v116 row_ror:8 row_mask:0xf bank_mask:0xf
    v_add_f32_dpp v118, v118, v118 row_ror:8 row_mask:0xf bank_mask:0xf
    s_nop 0
    v_add_f32_dpp v116, v116, v116 row_ror:4 row_mask:0xf bank_mask:0xf
    v_add_f32_dpp v118, v118, v118 row_ror:4 row_mask:0xf bank_mask:0xf
    s_nop 0
    v_add_f32_dpp v116, v116, v116 row_ror:2 row_mask:0xf bank_mask:0xf
    v_add_f32_dpp v118, v118, v118 row_ror:2 row_mask:0xf bank_mask:0xf
    s_nop 0
    v_add_f32_dpp v116, v116, v116 row_ror:1 row_mask:0xf bank_mask:0xf
    v_add_f32_dpp v118, v118, v118 row_ror:1 row_mask:0xf bank_mask:0xf
    v_mov_b32 v117, v116
    v_mov_b32 v119, v118
    s_nop 0
    v_permlane16_swap_b32 v117, v116
    v_permlane16_swap_b32 v119, v118
    v_add_f32 v116, v116, v117
    v_add_f32 v118, v118, v119
    v_mul_f32 v116, 0x3acccccd, v116
    v_mul_f32 v118, 0x3acccccd, v118
    v_fma_f32 v118, -v116, v116, v118
    v_max_f32 v118, 0, v118
    v_cvt_pk_bf16_f32 v116, v116, v116
    v_lshlrev_b32 v116, 16, v116
    v_cvt_pk_bf16_f32 v118, v118, v118
    v_lshlrev_b32 v118, 16, v118
    v_add_f32 v118, 0x3727c5ac, v118
    v_cvt_pk_bf16_f32 v118, v118, v118
    v_lshlrev_b32 v118, 16, v118
    v_sqrt_f32 v118, v118
    s_nop 0
    v_cvt_pk_bf16_f32 v118, v118, v118
    v_lshlrev_b32 v118, 16, v118
    v_rcp_f32 v118, v118
    v_mov_b32 v117, v116
    v_mov_b32 v119, v118
    s_nop 0
    v_permlane32_swap_b32 v116, v117
    v_permlane32_swap_b32 v118, v119
    s_waitcnt lgkmcnt(0)
    v_perm_b32 v8, v26, v24, s66
    v_perm_b32 v9, v30, v28, s66
    v_perm_b32 v10, v34, v32, s66
    v_perm_b32 v11, v38, v36, s66
    v_perm_b32 v12, v26, v24, s67
    v_perm_b32 v13, v30, v28, s67
    v_perm_b32 v14, v34, v32, s67
    v_perm_b32 v15, v38, v36, s67
    v_perm_b32 v16, v27, v25, s66
    v_perm_b32 v17, v31, v29, s66
    v_perm_b32 v18, v35, v33, s66
    v_perm_b32 v19, v39, v37, s66
    v_perm_b32 v20, v27, v25, s67
    v_perm_b32 v21, v31, v29, s67
    v_perm_b32 v22, v35, v33, s67
    v_perm_b32 v23, v39, v37, s67
    v_perm_b32 v24, v42, v40, s66
    v_perm_b32 v25, v46, v44, s66
    v_perm_b32 v26, v50, v48, s66
    v_perm_b32 v27, v54, v52, s66
    v_perm_b32 v28, v42, v40, s67
    v_perm_b32 v29, v46, v44, s67
    v_perm_b32 v30, v50, v48, s67
    v_perm_b32 v31, v54, v52, s67
    v_perm_b32 v32, v43, v41, s66
    v_perm_b32 v33, v47, v45, s66
    v_perm_b32 v34, v51, v49, s66
    v_perm_b32 v35, v55, v53, s66
    v_perm_b32 v36, v43, v41, s67
    v_perm_b32 v37, v47, v45, s67
    v_perm_b32 v38, v51, v49, s67
    v_perm_b32 v39, v55, v53, s67
    v_perm_b32 v40, v58, v56, s66
    v_perm_b32 v41, v62, v60, s66
    v_perm_b32 v42, v66, v64, s66
    v_perm_b32 v43, v70, v68, s66
    v_perm_b32 v44, v58, v56, s67
    v_perm_b32 v45, v62, v60, s67
    v_perm_b32 v46, v66, v64, s67
    v_perm_b32 v47, v70, v68, s67
    v_perm_b32 v48, v59, v57, s66
    v_perm_b32 v49, v63, v61, s66
    v_perm_b32 v50, v67, v65, s66
    v_perm_b32 v51, v71, v69, s66
    v_perm_b32 v52, v59, v57, s67
    v_perm_b32 v53, v63, v61, s67
    v_perm_b32 v54, v67, v65, s67
    v_perm_b32 v55, v71, v69, s67
    v_perm_b32 v56, v74, v72, s66
    v_perm_b32 v57, v78, v76, s66
    v_perm_b32 v58, v82, v80, s66
    v_perm_b32 v59, v86, v84, s66
    v_perm_b32 v60, v74, v72, s67
    v_perm_b32 v61, v78, v76, s67
    v_perm_b32 v62, v82, v80, s67
    v_perm_b32 v63, v86, v84, s67
    v_perm_b32 v64, v75, v73, s66
    v_perm_b32 v65, v79, v77, s66
    v_perm_b32 v66, v83, v81, s66
    v_perm_b32 v67, v87, v85, s66
    v_perm_b32 v68, v75, v73, s67
    v_perm_b32 v69, v79, v77, s67
    v_perm_b32 v70, v83, v81, s67
    v_perm_b32 v71, v87, v85, s67
    s_xor_b32 s68, s44, 1
    v_mov_b32 v113, s68
    v_mov_b32 v115, s68
    buffer_store_dwordx4 v[112:115], v4, s[60:63], s18 offen sc1
    buffer_store_dwordx4 v[112:115], v4, s[60:63], s19 offen sc1
    s_waitcnt vmcnt(0)
    buffer_load_dwordx4 v[72:75], v4, s[60:63], s28 offen offset:0 sc1
    buffer_load_dwordx4 v[76:79], v4, s[60:63], s28 offen offset:1024 sc1
    buffer_load_dwordx4 v[80:83], v4, s[60:63], s28 offen offset:2048 sc1
    buffer_load_dwordx4 v[84:87], v4, s[60:63], s28 offen offset:3072 sc1
    buffer_load_dwordx4 v[88:91], v4, s[60:63], s29 offen offset:0 sc1
    buffer_load_dwordx4 v[92:95], v4, s[60:63], s29 offen offset:1024 sc1
    buffer_load_dwordx4 v[96:99], v4, s[60:63], s29 offen offset:2048 sc1
    buffer_load_dwordx4 v[100:103], v4, s[60:63], s29 offen offset:3072 sc1
    buffer_load_dwordx4 v[104:107], v4, s[60:63], s30 offen offset:0 sc1
    buffer_load_dwordx4 v[108:111], v4, s[60:63], s30 offen offset:1024 sc1
    s_mov_b32 s69, 276736
    s_mov_b32 s31, 0
    s_cmp_eq_u32 s36, 0
    s_cbranch_scc1 L_D_nf
    s_mov_b32 s31, 1
    v_mov_b32 v112, 1
    s_mov_b64 exec, 1
    ds_add_u32 v0, v112 offset:60204
    s_mov_b64 exec, -1
L_D_nf:
L_D_chk:
    s_waitcnt vmcnt(0)
    v_xor_b32 v112, s44, v75
    v_bitop3_b32 v112, v112, v79, s44 bitop3:0xf6
    v_bitop3_b32 v112, v112, v83, s44 bitop3:0xf6
    v_bitop3_b32 v112, v112, v87, s44 bitop3:0xf6
    v_bitop3_b32 v112, v112, v91, s44 bitop3:0xf6
    v_bitop3_b32 v112, v112, v95, s44 bitop3:0xf6
    v_bitop3_b32 v112, v112, v99, s44 bitop3:0xf6
    v_bitop3_b32 v112, v112, v103, s44 bitop3:0xf6
    v_bitop3_b32 v112, v112, v107, s44 bitop3:0xf6
    v_bitop3_b32 v112, v112, v111, s44 bitop3:0xf6
    v_cmp_ne_u32 vcc, 0, v112
    s_cbranch_vccnz L_D_retry
    s_cmp_lg_u32 s31, 0
    s_cbranch_scc1 L_D_polled
    v_mov_b32 v112, 1
    s_mov_b64 exec, 1
    ds_add_u32 v0, v112 offset:60204
    s_mov_b64 exec, -1
L_D_polled:
    v_pk_add_f32 v[72:73], v[72:73], v[80:81]
    v_add_f32 v74, v74, v82
    v_pk_add_f32 v[76:77], v[76:77], v[84:85]
    v_add_f32 v78, v78, v86
    v_pk_add_f32 v[88:89], v[88:89], v[96:97]
    v_add_f32 v90, v90, v98
    v_pk_add_f32 v[92:93], v[92:93], v[100:101]
    v_add_f32 v94, v94, v102
    v_pk_add_f32 v[72:73], v[72:73], v[104:105]
    v_add_f32 v74, v74, v106
    v_pk_add_f32 v[76:77], v[76:77], v[108:109]
    v_add_f32 v78, v78, v110
    v_pk_add_f32 v[72:73], v[72:73], v[88:89]
    v_add_f32 v74, v74, v90
    v_pk_add_f32 v[76:77], v[76:77], v[92:93]
    v_add_f32 v78, v78, v94
    v_fma_f32 v72, -v116, v74, v72
    v_fma_f32 v73, -v117, v74, v73
    v_fma_f32 v76, -v116, v78, v76
    v_fma_f32 v77, -v117, v78, v77
    v_pk_mul_f32 v[72:73], v[72:73], v[118:119]
    v_pk_mul_f32 v[76:77], v[76:77], v[118:119]
    v_cvt_pk_bf16_f32 v80, v72, v73
    v_cvt_pk_bf16_f32 v81, v76, v77
    v_lshlrev_b32 v72, 16, v80
    v_and_b32 v73, s57, v80
    v_mul_f32 v82, 0xbfb8aa3b, v72
    v_mul_f32 v83, 0xbfb8aa3b, v73
    v_exp_f32 v82, v82
    v_exp_f32 v83, v83
    v_lshlrev_b32 v76, 16, v81
    v_and_b32 v77, s57, v81
    v_add_f32 v82, 1.0, v82
    v_add_f32 v83, 1.0, v83
    v_rcp_f32 v82, v82
    v_rcp_f32 v83, v83
    v_mul_f32 v72, v72, v82
    v_mul_f32 v73, v73, v83
    v_cvt_pk_bf16_f32 v80, v72, v73
    v_lshlrev_b32 v72, 16, v80
    v_and_b32 v73, s57, v80
    v_mul_f32 v72, v72, v76
    v_mul_f32 v73, v73, v77
    v_cvt_pk_bf16_f32 v80, v72, v73
    ds_write_b16 v6, v80 offset:60256
    ds_write_b16_d16_hi v6, v80 offset:60384
    ds_read_b128 v[112:115], v7 offset:60256
    ds_read_b128 v[116:119], v7 offset:60320
    s_waitcnt lgkmcnt(0)
    v_mfma_f32_16x16x32_bf16 v[84:87], v[112:115], v[20:23], 0
    v_mfma_f32_16x16x32_bf16 v[100:103], v[112:115], v[36:39], 0
    v_mfma_f32_16x16x32_bf16 v[72:75], v[112:115], v[8:11], 0
    v_mfma_f32_16x16x32_bf16 v[88:91], v[112:115], v[24:27], 0
    v_mfma_f32_16x16x32_bf16 v[76:79], v[112:115], v[12:15], 0
    v_mfma_f32_16x16x32_bf16 v[92:95], v[112:115], v[28:31], 0
    v_mfma_f32_16x16x32_bf16 v[80:83], v[112:115], v[16:19], 0
    v_mfma_f32_16x16x32_bf16 v[96:99], v[112:115], v[32:35], 0
    v_mfma_f32_16x16x32_bf16 v[84:87], v[116:119], v[52:55], v[84:87]
    v_mfma_f32_16x16x32_bf16 v[100:103], v[116:119], v[68:71], v[100:103]
    v_mfma_f32_16x16x32_bf16 v[72:75], v[116:119], v[40:43], v[72:75]
    v_mfma_f32_16x16x32_bf16 v[88:91], v[116:119], v[56:59], v[88:91]
    v_mfma_f32_16x16x32_bf16 v[76:79], v[116:119], v[44:47], v[76:79]
    v_mfma_f32_16x16x32_bf16 v[92:95], v[116:119], v[60:63], v[92:95]
    v_mfma_f32_16x16x32_bf16 v[80:83], v[116:119], v[48:51], v[80:83]
    v_mfma_f32_16x16x32_bf16 v[96:99], v[116:119], v[64:67], v[96:99]
    s_nop 1
    v_cndmask_b32 v124, v84, v100, s[4:5]
    v_cndmask_b32 v124, v124, v85, s[6:7]
    v_cndmask_b32 v124, v124, v101, s[8:9]
    v_cndmask_b32 v120, v72, v88, s[4:5]
    v_cndmask_b32 v120, v120, v73, s[6:7]
    v_cndmask_b32 v120, v120, v89, s[8:9]
    v_cndmask_b32 v121, v76, v92, s[4:5]
    v_cndmask_b32 v121, v121, v77, s[6:7]
    v_cndmask_b32 v121, v121, v93, s[8:9]
    v_cndmask_b32 v122, v80, v96, s[4:5]
    v_cndmask_b32 v122, v122, v81, s[6:7]
    v_cndmask_b32 v122, v122, v97, s[8:9]
    v_perm_b32 v120, v124, v120, s10
    v_perm_b32 v121, v124, v121, s11
    v_perm_b32 v122, v124, v122, s35
    buffer_store_dwordx4 v[120:123], v4, s[60:63], s18 offen sc1
    buffer_store_dwordx4 v[120:123], v4, s[60:63], s19 offen sc1
    s_endpgm
L_D_retry:
    s_add_u32 s28, s28, s69
    s_add_u32 s29, s29, s69
    s_add_u32 s30, s30, s69
    s_sub_u32 s69, 0, s69
    v_cmp_ne_u32 vcc, s44, v75
    s_cbranch_vccz L_D_s0
    buffer_load_dwordx4 v[72:75], v4, s[60:63], s28 offen offset:0 sc1
L_D_s0:
    v_cmp_ne_u32 vcc, s44, v79
    s_cbranch_vccz L_D_s1
    buffer_load_dwordx4 v[76:79], v4, s[60:63], s28 offen offset:1024 sc1
L_D_s1:
    v_cmp_ne_u32 vcc, s44, v83
    s_cbranch_vccz L_D_s2
    buffer_load_dwordx4 v[80:83], v4, s[60:63], s28 offen offset:2048 sc1
L_D_s2:
    v_cmp_ne_u32 vcc, s44, v87
    s_cbranch_vccz L_D_s3
    buffer_load_dwordx4 v[84:87], v4, s[60:63], s28 offen offset:3072 sc1
L_D_s3:
    v_cmp_ne_u32 vcc, s44, v91
    s_cbranch_vccz L_D_s4
    buffer_load_dwordx4 v[88:91], v4, s[60:63], s29 offen offset:0 sc1
L_D_s4:
    v_cmp_ne_u32 vcc, s44, v95
    s_cbranch_vccz L_D_s5
    buffer_load_dwordx4 v[92:95], v4, s[60:63], s29 offen offset:1024 sc1
L_D_s5:
    v_cmp_ne_u32 vcc, s44, v99
    s_cbranch_vccz L_D_s6
    buffer_load_dwordx4 v[96:99], v4, s[60:63], s29 offen offset:2048 sc1
L_D_s6:
    v_cmp_ne_u32 vcc, s44, v103
    s_cbranch_vccz L_D_s7
    buffer_load_dwordx4 v[100:103], v4, s[60:63], s29 offen offset:3072 sc1
L_D_s7:
    v_cmp_ne_u32 vcc, s44, v107
    s_cbranch_vccz L_D_s8
    buffer_load_dwordx4 v[104:107], v4, s[60:63], s30 offen offset:0 sc1
L_D_s8:
    v_cmp_ne_u32 vcc, s44, v111
    s_cbranch_vccz L_D_s9
    buffer_load_dwordx4 v[108:111], v4, s[60:63], s30 offen offset:1024 sc1
L_D_s9:
    s_cmp_lg_u32 s31, 0
    s_cbranch_scc1 L_D_r2
    s_mov_b32 s31, 1
    v_mov_b32 v112, 1
    s_mov_b64 exec, 1
    ds_add_u32 v0, v112 offset:60204
    s_mov_b64 exec, -1
L_D_r2:
    s_sub_u32 s58, s58, 1
    s_cmp_lg_u32 s58, 0
    s_cbranch_scc1 L_D_chk
    s_endpgm
L_Z_xonly:
    s_mov_b64 exec, 1
    ds_add_u32 v0, v104 offset:60204
    s_mov_b64 exec, -1
L_Z_end:
    s_waitcnt lgkmcnt(0)
    s_endpgm
L_Z_miss:
    s_mul_i32 s65, s64, 4352
    s_add_u32 s65, s65, 8192
    s_add_u32 s32, s65, 1024
    s_add_u32 s33, s65, 2048
    s_add_u32 s34, s65, 3072
    s_add_u32 s64, s64, 1
    s_and_b32 s64, s64, 15
    s_mov_b64 exec, s[20:21]
    s_cbranch_execz L_zzb0
    buffer_load_dwordx4 v[88:91], v4, s[60:63], s65 offen sc1
L_zzb0:
    s_mov_b64 exec, s[22:23]
    s_cbranch_execz L_zzb1
    buffer_load_dwordx4 v[92:95], v4, s[60:63], s32 offen sc1
L_zzb1:
    s_mov_b64 exec, s[24:25]
    s_cbranch_execz L_zzb2
    buffer_load_dwordx4 v[96:99], v4, s[60:63], s33 offen sc1
L_zzb2:
    s_mov_b64 exec, s[26:27]
    s_cbranch_execz L_zzb3
    buffer_load_dwordx4 v[100:103], v4, s[60:63], s34 offen sc1
L_zzb3:
    s_mov_b64 exec, -1
    s_sub_u32 s58, s58, 1
    s_cmp_eq_u32 s58, 0
    s_cbranch_scc1 L_Z_kd
    s_waitcnt vmcnt(0)
    s_branch L_Z_chk
L_bump:
    s_lshl_b32 s64, s2, 4
    s_add_u32 s64, s64, s45
    s_cmp_eq_u32 s64, 9
    s_cbranch_scc1 L_bump2
    s_cmp_lg_u32 s45, 8
    s_cbranch_scc1 L_end
    v_mov_b32 v6, 0
    s_waitcnt vmcnt(0)
    s_barrier
L_h8:
    ds_read_b32 v25, v6 offset:60196
    s_waitcnt lgkmcnt(0)
    v_readfirstlane_b32 s73, v25
    s_nop 0
    s_cmp_ge_u32 s73, 1
    s_cbranch_scc1 L_h8_ok
    s_sleep 4
    s_sub_u32 s58, s58, 1
    s_cmp_lg_u32 s58, 0
    s_cbranch_scc1 L_h8
L_h8_ok:
    s_mov_b32 s58, 2000000
    s_branch L_hprep
L_bump2:
    v_mul_u32_u24 v5, 1792, v1
    s_mov_b32 s72, 3145740
    s_barrier
L_bw:
    ds_read_b32 v25, v0 offset:60208
    s_waitcnt lgkmcnt(0)
    v_readfirstlane_b32 s73, v25
    s_nop 0
    s_cmp_ge_u32 s73, 458759
    s_cbranch_scc1 L_bw_ok
    s_sleep 8
    s_sub_u32 s58, s58, 1
    s_cmp_lg_u32 s58, 0
    s_cbranch_scc1 L_bw
L_bw_ok:
    s_mov_b32 s58, 2000000
L_B_poll:
    buffer_load_dword v8, v5, s[60:63], s72 offen sc1
    buffer_load_dword v9, v5, s[60:63], s72 offen offset:64 sc1
    s_waitcnt vmcnt(0)
    v_xor_b32 v10, s44, v8
    v_bitop3_b32 v10, v10, v9, s44 bitop3:0xf6
    v_cmp_ne_u32 vcc, 0, v10
    s_cbranch_vccz L_B_done
    s_sleep 4
    s_sub_u32 s58, s58, 1
    s_cmp_lg_u32 s58, 0
    s_cbranch_scc1 L_B_poll
L_B_done:
    v_mov_b32 v6, s44
    s_mov_b64 exec, 1
    buffer_store_dword v6, v0, s[60:63], 0 offen sc1
L_end:
    s_endpgm
    .p2align 7
    .type L_tab0,@object
L_tab0:
    .set L_tab, L_tab0+2048
    .long 0x3f80, 0x0, 0x0, 0x0, 0x3f800000, 0x0, 0x0, 0x0
    .long 0x0, 0x3f80, 0x0, 0x0, 0x0, 0x3f800000, 0x0, 0x0
    .long 0x0, 0x0, 0x0, 0x0, 0x0, 0x0, 0x0, 0x0
    .long 0x0, 0x0, 0x0, 0x0, 0x0, 0x0, 0x0, 0x0
    .long 0x0, 0x0, 0x3f80, 0x0, 0x0, 0x0, 0x3f800000, 0x0
    .long 0x0, 0x0, 0x0, 0x3f80, 0x0, 0x0, 0x0, 0x3f800000
    .long 0x0, 0x0, 0x0, 0x0, 0x0, 0x0, 0x0, 0x0
    .long 0x0, 0x0, 0x0, 0x0, 0x0, 0x0, 0x0, 0x0
    .long 0x0, 0x0, 0x0, 0x0, 0x3f800000, 0x0, 0x0, 0x0
    .long 0x0, 0x3f80, 0x0, 0x0, 0x0, 0x3f800000, 0x0, 0x0
    .long 0x0, 0x0, 0x0, 0x0, 0x0, 0x0, 0x0, 0x0
    .long 0x0, 0x0, 0x0, 0x0, 0x0, 0x0, 0x0, 0x0
    .long 0x0, 0x0, 0x3f80, 0x0, 0x0, 0x0, 0x3f800000, 0x0
    .long 0x0, 0x0, 0x0, 0x3f80, 0x0, 0x0, 0x0, 0x3f800000
    .long 0x0, 0x0, 0x0, 0x0, 0x0, 0x0, 0x0, 0x0
    .long 0x0, 0x0, 0x0, 0x0, 0x0, 0x0, 0x0, 0x0
    .long 0x0, 0x0, 0x0, 0x0, 0x0, 0x0, 0x0, 0x0
    .long 0x0, 0x0, 0x0, 0x0, 0x0, 0x0, 0x0, 0x0
    .long 0x3f80, 0x0, 0x0, 0x0, 0x3f800000, 0x0, 0x0, 0x0
    .long 0x0, 0x3f80, 0x0, 0x0, 0x0, 0x3f800000, 0x0, 0x0
    .long 0x0, 0x0, 0x0, 0x0, 0x0, 0x0, 0x0, 0x0
    .long 0x0, 0x0, 0x0, 0x0, 0x0, 0x0, 0x0, 0x0
    .long 0x0, 0x0, 0x3f80, 0x0, 0x0, 0x0, 0x3f800000, 0x0
    .long 0x0, 0x0, 0x0, 0x3f80, 0x0, 0x0, 0x0, 0x3f800000
    .long 0x0, 0x0, 0x0, 0x0, 0x0, 0x0, 0x0, 0x0
    .long 0x0, 0x0, 0x0, 0x0, 0x0, 0x0, 0x0, 0x0
    .long 0x0, 0x0, 0x0, 0x0, 0x3f800000, 0x0, 0x0, 0x0
    .long 0x0, 0x3f80, 0x0, 0x0, 0x0, 0x3f800000, 0x0, 0x0
    .long 0x0, 0x0, 0x0, 0x0, 0x0, 0x0, 0x0, 0x0
    .long 0x0, 0x0, 0x0, 0x0, 0x0, 0x0, 0x0, 0x0
    .long 0x0, 0x0, 0x3f80, 0x0, 0x0, 0x0, 0x3f800000, 0x0
    .long 0x0, 0x0, 0x0, 0x3f80, 0x0, 0x0, 0x0, 0x3f800000
    .long 0x3f80, 0x0, 0x0, 0x0, 0x3f800000, 0x0, 0x0, 0x0
    .long 0x0, 0x3f80, 0x0, 0x0, 0x0, 0x3f800000, 0x0, 0x0
    .long 0x0, 0x0, 0x0, 0x0, 0x0, 0x0, 0x0, 0x0
    .long 0x0, 0x0, 0x0, 0x0, 0x0, 0x0, 0x0, 0x0
    .long 0x0, 0x0, 0x3f80, 0x0, 0x0, 0x0, 0x3f800000, 0x0
    .long 0x0, 0x0, 0x0, 0x3f80, 0x0, 0x0, 0x0, 0x3f800000
    .long 0x0, 0x0, 0x0, 0x0, 0x0, 0x0, 0x0, 0x0
    .long 0x0, 0x0, 0x0, 0x0, 0x0, 0x0, 0x0, 0x0
    .long 0x0, 0x0, 0x0, 0x0, 0x3f800000, 0x0, 0x0, 0x0
    .long 0x0, 0x3f80, 0x0, 0x0, 0x0, 0x3f800000, 0x0, 0x0
    .long 0x0, 0x0, 0x0, 0x0, 0x0, 0x0, 0x0, 0x0
    .long 0x0, 0x0, 0x0, 0x0, 0x0, 0x0, 0x0, 0x0
    .long 0x0, 0x0, 0x3f80, 0x0, 0x0, 0x0, 0x3f800000, 0x0
    .long 0x0, 0x0, 0x0, 0x3f80, 0x0, 0x0, 0x0, 0x3f800000
    .long 0x0, 0x0, 0x0, 0x0, 0x0, 0x0, 0x0, 0x0
    .long 0x0, 0x0, 0x0, 0x0, 0x0, 0x0, 0x0, 0x0
    .long 0x0, 0x0, 0x0, 0x0, 0x0, 0x0, 0x0, 0x0
    .long 0x0, 0x0, 0x0, 0x0, 0x0, 0x0, 0x0, 0x0
    .long 0x3f80, 0x0, 0x0, 0x0, 0x3f800000, 0x0, 0x0, 0x0
    .long 0x0, 0x3f80, 0x0, 0x0, 0x0, 0x3f800000, 0x0, 0x0
    .long 0x0, 0x0, 0x0, 0x0, 0x0, 0x0, 0x0, 0x0
    .long 0x0, 0x0, 0x0, 0x0, 0x0, 0x0, 0x0, 0x0
    .long 0x0, 0x0, 0x3f80, 0x0, 0x0, 0x0, 0x3f800000, 0x0
    .long 0x0, 0x0, 0x0, 0x3f80, 0x0, 0x0, 0x0, 0x3f800000
    .long 0x0, 0x0, 0x0, 0x0, 0x0, 0x0, 0x0, 0x0
    .long 0x0, 0x0, 0x0, 0x0, 0x0, 0x0, 0x0, 0x0
    .long 0x0, 0x0, 0x0, 0x0, 0x3f800000, 0x0, 0x0, 0x0
    .long 0x0, 0x3f80, 0x0, 0x0, 0x0, 0x3f800000, 0x0, 0x0
    .long 0x0, 0x0, 0x0, 0x0, 0x0, 0x0, 0x0, 0x0
    .long 0x0, 0x0, 0x0, 0x0, 0x0, 0x0, 0x0, 0x0
    .long 0x0, 0x0, 0x3f80, 0x0, 0x0, 0x0, 0x3f800000, 0x0
    .long 0x0, 0x0, 0x0, 0x3f80, 0x0, 0x0, 0x0, 0x3f800000
    .long 0x0, 0x0, 0x0, 0x0, 0x0, 0x0, 0x0, 0x3f800000
    .long 0x0, 0x0, 0x0, 0x3f80, 0x0, 0x0, 0x3f800000, 0x0
    .long 0x0, 0x0, 0x0, 0x0, 0x0, 0x0, 0x0, 0x0
    .long 0x0, 0x0, 0x0, 0x0, 0x0, 0x0, 0x0, 0x0
    .long 0x0, 0x0, 0x3f80, 0x0, 0x0, 0x3f800000, 0x0, 0x0
    .long 0x0, 0x3f80, 0x0, 0x0, 0x3f800000, 0x0, 0x0, 0x0
    .long 0x0, 0x0, 0x0, 0x0, 0x0, 0x0, 0x0, 0x0
    .long 0x0, 0x0, 0x0, 0x0, 0x0, 0x0, 0x0, 0x0
    .long 0x3f80, 0x0, 0x0, 0x0, 0x0, 0x0, 0x0, 0xbf800000
    .long 0x0, 0x0, 0x0, 0xbf80, 0x0, 0x0, 0xbf800000, 0x0
    .long 0x0, 0x0, 0x0, 0x0, 0x0, 0x0, 0x0, 0x0
    .long 0x0, 0x0, 0x0, 0x0, 0x0, 0x0, 0x0, 0x0
    .long 0x0, 0x0, 0xbf80, 0x0, 0x0, 0xbf800000, 0x0, 0x0
    .long 0x0, 0xbf80, 0x0, 0x0, 0xbf800000, 0x0, 0x0, 0x0
    .long 0x0, 0x0, 0x0, 0x0, 0x0, 0x0, 0x0, 0x0
    .long 0x0, 0x0, 0x0, 0x0, 0x0, 0x0, 0x0, 0x0
    .long 0x0, 0x0, 0x0, 0x0, 0x0, 0x0, 0x0, 0x0
    .long 0x0, 0x0, 0x0, 0x0, 0x0, 0x0, 0x0, 0x0
    .long 0x0, 0x0, 0x0, 0x0, 0x0, 0x0, 0x0, 0x3f800000
    .long 0x0, 0x0, 0x0, 0x3f80, 0x0, 0x0, 0x3f800000, 0x0
    .long 0x0, 0x0, 0x0, 0x0, 0x0, 0x0, 0x0, 0x0
    .long 0x0, 0x0, 0x0, 0x0, 0x0, 0x0, 0x0, 0x0
    .long 0x0, 0x0, 0x3f80, 0x0, 0x0, 0x3f800000, 0x0, 0x0
    .long 0x0, 0x3f80, 0x0, 0x0, 0x3f800000, 0x0, 0x0, 0x0
    .long 0x0, 0x0, 0x0, 0x0, 0x0, 0x0, 0x0, 0x0
    .long 0x0, 0x0, 0x0, 0x0, 0x0, 0x0, 0x0, 0x0
    .long 0x3f80, 0x0, 0x0, 0x0, 0x0, 0x0, 0x0, 0xbf800000
    .long 0x0, 0x0, 0x0, 0xbf80, 0x0, 0x0, 0xbf800000, 0x0
    .long 0x0, 0x0, 0x0, 0x0, 0x0, 0x0, 0x0, 0x0
    .long 0x0, 0x0, 0x0, 0x0, 0x0, 0x0, 0x0, 0x0
    .long 0x0, 0x0, 0xbf80, 0x0, 0x0, 0xbf800000, 0x0, 0x0
    .long 0x0, 0xbf80, 0x0, 0x0, 0xbf800000, 0x0, 0x0, 0x0
    .long 0x0, 0x0, 0x0, 0x0, 0x0, 0x0, 0x0, 0x3f800000
    .long 0x0, 0x0, 0x0, 0x3f80, 0x0, 0x0, 0x3f800000, 0x0
    .long 0x0, 0x0, 0x0, 0x0, 0x0, 0x0, 0x0, 0x0
    .long 0x0, 0x0, 0x0, 0x0, 0x0, 0x0, 0x0, 0x0
    .long 0x0, 0x0, 0x3f80, 0x0, 0x0, 0x3f800000, 0x0, 0x0
    .long 0x0, 0x3f80, 0x0, 0x0, 0x3f800000, 0x0, 0x0, 0x0
    .long 0x0, 0x0, 0x0, 0x0, 0x0, 0x0, 0x0, 0x0
    .long 0x0, 0x0, 0x0, 0x0, 0x0, 0x0, 0x0, 0x0
    .long 0x3f80, 0x0, 0x0, 0x0, 0x0, 0x0, 0x0, 0xbf800000
    .long 0x0, 0x0, 0x0, 0xbf80, 0x0, 0x0, 0xbf800000, 0x0
    .long 0x0, 0x0, 0x0, 0x0, 0x0, 0x0, 0x0, 0x0
    .long 0x0, 0x0, 0x0, 0x0, 0x0, 0x0, 0x0, 0x0
    .long 0x0, 0x0, 0xbf80, 0x0, 0x0, 0xbf800000, 0x0, 0x0
    .long 0x0, 0xbf80, 0x0, 0x0, 0xbf800000, 0x0, 0x0, 0x0
    .long 0x0, 0x0, 0x0, 0x0, 0x0, 0x0, 0x0, 0x0
    .long 0x0, 0x0, 0x0, 0x0, 0x0, 0x0, 0x0, 0x0
    .long 0x0, 0x0, 0x0, 0x0, 0x0, 0x0, 0x0, 0x0
    .long 0x0, 0x0, 0x0, 0x0, 0x0, 0x0, 0x0, 0x0
    .long 0x0, 0x0, 0x0, 0x0, 0x0, 0x0, 0x0, 0x3f800000
    .long 0x0, 0x0, 0x0, 0x3f80, 0x0, 0x0, 0x3f800000, 0x0
    .long 0x0, 0x0, 0x0, 0x0, 0x0, 0x0, 0x0, 0x0
    .long 0x0, 0x0, 0x0, 0x0, 0x0, 0x0, 0x0, 0x0
    .long 0x0, 0x0, 0x3f80, 0x0, 0x0, 0x3f800000, 0x0, 0x0
    .long 0x0, 0x3f80, 0x0, 0x0, 0x3f800000, 0x0, 0x0, 0x0
    .long 0x0, 0x0, 0x0, 0x0, 0x0, 0x0, 0x0, 0x0
    .long 0x0, 0x0, 0x0, 0x0, 0x0, 0x0, 0x0, 0x0
    .long 0x3f80, 0x0, 0x0, 0x0, 0x0, 0x0, 0x0, 0xbf800000
    .long 0x0, 0x0, 0x0, 0xbf80, 0x0, 0x0, 0xbf800000, 0x0
    .long 0x0, 0x0, 0x0, 0x0, 0x0, 0x0, 0x0, 0x0
    .long 0x0, 0x0, 0x0, 0x0, 0x0, 0x0, 0x0, 0x0
    .long 0x0, 0x0, 0xbf80, 0x0, 0x0, 0xbf800000, 0x0, 0x0
    .long 0x0, 0xbf80, 0x0, 0x0, 0xbf800000, 0x0, 0x0, 0x0
    .long 0x3f80, 0x3f80, 0x0, 0x0, 0x3f800000, 0x3f800000, 0x3f800000, 0x3f800000
    .long 0x0, 0x0, 0x3f80, 0x3f80, 0x3f800000, 0x3f800000, 0xbf800000, 0xbf800000
    .long 0x0, 0x0, 0x0, 0x0, 0x0, 0x0, 0x0, 0x0
    .long 0x0, 0x0, 0x0, 0x0, 0x0, 0x0, 0x0, 0x0
    .long 0x0, 0x0, 0x0, 0x0, 0x0, 0x0, 0x0, 0x0
    .long 0x0, 0x0, 0x0, 0x0, 0x0, 0x0, 0x0, 0x0
    .long 0x0, 0x0, 0x0, 0x0, 0x0, 0x0, 0x0, 0x0
    .long 0x0, 0x0, 0x0, 0x0, 0x0, 0x0, 0x0, 0x0
    .long 0x0, 0x0, 0x0, 0x0, 0x0, 0x0, 0x0, 0x0
    .long 0x0, 0x0, 0x0, 0x0, 0x0, 0x0, 0x0, 0x0
    .long 0x3f80, 0x3f80, 0x0, 0x0, 0x3f800000, 0x3f800000, 0x3f800000, 0x3f800000
    .long 0x0, 0x0, 0x3f80, 0x3f80, 0x3f800000, 0x3f800000, 0xbf800000, 0xbf800000
    .long 0x0, 0x0, 0x0, 0x0, 0x0, 0x0, 0x0, 0x0
    .long 0x0, 0x0, 0x0, 0x0, 0x0, 0x0, 0x0, 0x0
    .long 0x0, 0x0, 0x0, 0x0, 0x0, 0x0, 0x0, 0x0
    .long 0x0, 0x0, 0x0, 0x0, 0x0, 0x0, 0x0, 0x0
    .long 0x0, 0x0, 0x0, 0x0, 0x0, 0x0, 0x0, 0x0
    .long 0x0, 0x0, 0x0, 0x0, 0x0, 0x0, 0x0, 0x0
    .long 0x0, 0x0, 0x0, 0x0, 0x0, 0x0, 0x0, 0x0
    .long 0x0, 0x0, 0x0, 0x0, 0x0, 0x0, 0x0, 0x0
    .long 0x3f80, 0x3f80, 0x0, 0x0, 0x3f800000, 0x3f800000, 0x3f800000, 0x3f800000
    .long 0x0, 0x0, 0x3f80, 0x3f80, 0x3f800000, 0x3f800000, 0xbf800000, 0xbf800000
    .long 0x0, 0x0, 0x0, 0x0, 0x0, 0x0, 0x0, 0x0
    .long 0x0, 0x0, 0x0, 0x0, 0x0, 0x0, 0x0, 0x0
    .long 0x0, 0x0, 0x0, 0x0, 0x0, 0x0, 0x0, 0x0
    .long 0x0, 0x0, 0x0, 0x0, 0x0, 0x0, 0x0, 0x0
    .long 0x0, 0x0, 0x0, 0x0, 0x0, 0x0, 0x0, 0x0
    .long 0x0, 0x0, 0x0, 0x0, 0x0, 0x0, 0x0, 0x0
    .long 0x0, 0x0, 0x0, 0x0, 0x0, 0x0, 0x0, 0x0
    .long 0x0, 0x0, 0x0, 0x0, 0x0, 0x0, 0x0, 0x0
    .long 0x3f80, 0x3f80, 0x0, 0x0, 0x3f800000, 0x3f800000, 0x3f800000, 0x3f800000
    .long 0x0, 0x0, 0x3f80, 0x3f80, 0x3f800000, 0x3f800000, 0xbf800000, 0xbf800000
    .long 0x3f80, 0x0, 0x0, 0x0, 0x3f800000, 0x0, 0x0, 0x0
    .long 0x0, 0x3f80, 0x0, 0x0, 0x0, 0x3f800000, 0x0, 0x0
    .long 0x0, 0x0, 0x0, 0x0, 0x0, 0x0, 0x0, 0x0
    .long 0x0, 0x0, 0x0, 0x0, 0x0, 0x0, 0x0, 0x0
    .long 0x0, 0x0, 0x3f80, 0x0, 0x0, 0x0, 0x3f800000, 0x0
    .long 0x0, 0x0, 0x0, 0x3f80, 0x0, 0x0, 0x0, 0x3f800000
    .long 0x0, 0x0, 0x0, 0x0, 0x0, 0x0, 0x0, 0x0
    .long 0x0, 0x0, 0x0, 0x0, 0x0, 0x0, 0x0, 0x0
    .long 0x0, 0x0, 0x0, 0x0, 0x3f800000, 0x0, 0x0, 0x0
    .long 0x0, 0x3f80, 0x0, 0x0, 0x0, 0x3f800000, 0x0, 0x0
    .long 0x0, 0x0, 0x0, 0x0, 0x0, 0x0, 0x0, 0x0
    .long 0x0, 0x0, 0x0, 0x0, 0x0, 0x0, 0x0, 0x0
    .long 0x0, 0x0, 0x3f80, 0x0, 0x0, 0x0, 0x3f800000, 0x0
    .long 0x0, 0x0, 0x0, 0x3f80, 0x0, 0x0, 0x0, 0x3f800000
    .long 0x0, 0x0, 0x0, 0x0, 0x0, 0x0, 0x0, 0x0
    .long 0x0, 0x0, 0x0, 0x0, 0x0, 0x0, 0x0, 0x0
    .long 0x0, 0x0, 0x0, 0x0, 0x0, 0x0, 0x0, 0x0
    .long 0x0, 0x0, 0x0, 0x0, 0x0, 0x0, 0x0, 0x0
    .long 0x3f80, 0x0, 0x0, 0x0, 0x3f800000, 0x0, 0x0, 0x0
    .long 0x0, 0x3f80, 0x0, 0x0, 0x0, 0x3f800000, 0x0, 0x0
    .long 0x0, 0x0, 0x0, 0x0, 0x0, 0x0, 0x0, 0x0
    .long 0x0, 0x0, 0x0, 0x0, 0x0, 0x0, 0x0, 0x0
    .long 0x0, 0x0, 0x3f80, 0x0, 0x0, 0x0, 0x3f800000, 0x0
    .long 0x0, 0x0, 0x0, 0x3f80, 0x0, 0x0, 0x0, 0x3f800000
    .long 0x0, 0x0, 0x0, 0x0, 0x0, 0x0, 0x0, 0x0
    .long 0x0, 0x0, 0x0, 0x0, 0x0, 0x0, 0x0, 0x0
    .long 0x0, 0x0, 0x0, 0x0, 0x3f800000, 0x0, 0x0, 0x0
    .long 0x0, 0x3f80, 0x0, 0x0, 0x0, 0x3f800000, 0x0, 0x0
    .long 0x0, 0x0, 0x0, 0x0, 0x0, 0x0, 0x0, 0x0
    .long 0x0, 0x0, 0x0, 0x0, 0x0, 0x0, 0x0, 0x0
    .long 0x0, 0x0, 0x3f80, 0x0, 0x0, 0x0, 0x3f800000, 0x0
    .long 0x0, 0x0, 0x0, 0x3f80, 0x0, 0x0, 0x0, 0x3f800000
    .long 0x8000bf80, 0x80008000, 0x80008000, 0x80008000, 0xbf808000, 0x80008000, 0x80008000, 0x80008000
    .long 0x80008000, 0x8000bf80, 0x80008000, 0x80008000, 0x80008000, 0xbf808000, 0x80008000, 0x80008000
    .long 0x80008000, 0x80008000, 0x80008000, 0x80008000, 0x80008000, 0x80008000, 0x80008000, 0x80008000
    .long 0x80008000, 0x80008000, 0x80008000, 0x80008000, 0x80008000, 0x80008000, 0x80008000, 0x80008000
    .long 0x80008000, 0x80008000, 0x8000bf80, 0x80008000, 0x80008000, 0x80008000, 0xbf808000, 0x80008000
    .long 0x80008000, 0x80008000, 0x80008000, 0x8000bf80, 0x80008000, 0x80008000, 0x80008000, 0xbf808000
    .long 0x80008000, 0x80008000, 0x80008000, 0x80008000, 0x80008000, 0x80008000, 0x80008000, 0x80008000
    .long 0x80008000, 0x80008000, 0x80008000, 0x80008000, 0x80008000, 0x80008000, 0x80008000, 0x80008000
    .long 0x80008000, 0x80008000, 0x80008000, 0x80008000, 0xbf808000, 0x80008000, 0x80008000, 0x80008000
    .long 0x80008000, 0x8000bf80, 0x80008000, 0x80008000, 0x80008000, 0xbf808000, 0x80008000, 0x80008000
    .long 0x80008000, 0x80008000, 0x80008000, 0x80008000, 0x80008000, 0x80008000, 0x80008000, 0x80008000
    .long 0x80008000, 0x80008000, 0x80008000, 0x80008000, 0x80008000, 0x80008000, 0x80008000, 0x80008000
    .long 0x80008000, 0x80008000, 0x8000bf80, 0x80008000, 0x80008000, 0x80008000, 0xbf808000, 0x80008000
    .long 0x80008000, 0x80008000, 0x80008000, 0x8000bf80, 0x80008000, 0x80008000, 0x80008000, 0xbf808000
    .long 0x80008000, 0x80008000, 0x80008000, 0x80008000, 0x80008000, 0x80008000, 0x80008000, 0x80008000
    .long 0x80008000, 0x80008000, 0x80008000, 0x80008000, 0x80008000, 0x80008000, 0x80008000, 0x80008000
    .long 0x80008000, 0x80008000, 0x80008000, 0x80008000, 0x80008000, 0x80008000, 0x80008000, 0x80008000
    .long 0x80008000, 0x80008000, 0x80008000, 0x80008000, 0x80008000, 0x80008000, 0x80008000, 0x80008000
    .long 0x8000bf80, 0x80008000, 0x80008000, 0x80008000, 0xbf808000, 0x80008000, 0x80008000, 0x80008000
    .long 0x80008000, 0x8000bf80, 0x80008000, 0x80008000, 0x80008000, 0xbf808000, 0x80008000, 0x80008000
    .long 0x80008000, 0x80008000, 0x80008000, 0x80008000, 0x80008000, 0x80008000, 0x80008000, 0x80008000
    .long 0x80008000, 0x80008000, 0x80008000, 0x80008000, 0x80008000, 0x80008000, 0x80008000, 0x80008000
    .long 0x80008000, 0x80008000, 0x8000bf80, 0x80008000, 0x80008000, 0x80008000, 0xbf808000, 0x80008000
    .long 0x80008000, 0x80008000, 0x80008000, 0x8000bf80, 0x80008000, 0x80008000, 0x80008000, 0xbf808000
    .long 0x80008000, 0x80008000, 0x80008000, 0x80008000, 0x80008000, 0x80008000, 0x80008000, 0x80008000
    .long 0x80008000, 0x80008000, 0x80008000, 0x80008000, 0x80008000, 0x80008000, 0x80008000, 0x80008000
    .long 0x80008000, 0x80008000, 0x80008000, 0x80008000, 0xbf808000, 0x80008000, 0x80008000, 0x80008000
    .long 0x80008000, 0x8000bf80, 0x80008000, 0x80008000, 0x80008000, 0xbf808000, 0x80008000, 0x80008000
    .long 0x80008000, 0x80008000, 0x80008000, 0x80008000, 0x80008000, 0x80008000, 0x80008000, 0x80008000
    .long 0x80008000, 0x80008000, 0x80008000, 0x80008000, 0x80008000, 0x80008000, 0x80008000, 0x80008000
    .long 0x80008000, 0x80008000, 0x8000bf80, 0x80008000, 0x80008000, 0x80008000, 0xbf808000, 0x80008000
    .long 0x80008000, 0x80008000, 0x80008000, 0x8000bf80, 0x80008000, 0x80008000, 0x80008000, 0xbf808000
    .long 0x0, 0x0, 0x0, 0x0, 0x0, 0x0, 0x0, 0x3f800000
    .long 0x0, 0x0, 0x0, 0x3f80, 0x0, 0x0, 0x3f800000, 0x0
    .long 0x0, 0x0, 0x0, 0x0, 0x0, 0x0, 0x0, 0x0
    .long 0x0, 0x0, 0x0, 0x0, 0x0, 0x0, 0x0, 0x0
    .long 0x0, 0x0, 0x3f80, 0x0, 0x0, 0x3f800000, 0x0, 0x0
    .long 0x0, 0x3f80, 0x0, 0x0, 0x3f800000, 0x0, 0x0, 0x0
    .long 0x0, 0x0, 0x0, 0x0, 0x0, 0x0, 0x0, 0x0
    .long 0x0, 0x0, 0x0, 0x0, 0x0, 0x0, 0x0, 0x0
    .long 0x3f80, 0x0, 0x0, 0x0, 0x0, 0x0, 0x0, 0xbf800000
    .long 0x0, 0x0, 0x0, 0xbf80, 0x0, 0x0, 0xbf800000, 0x0
    .long 0x0, 0x0, 0x0, 0x0, 0x0, 0x0, 0x0, 0x0
    .long 0x0, 0x0, 0x0, 0x0, 0x0, 0x0, 0x0, 0x0
    .long 0x0, 0x0, 0xbf80, 0x0, 0x0, 0xbf800000, 0x0, 0x0
    .long 0x0, 0xbf80, 0x0, 0x0, 0xbf800000, 0x0, 0x0, 0x0
    .long 0x0, 0x0, 0x0, 0x0, 0x0, 0x0, 0x0, 0x0
    .long 0x0, 0x0, 0x0, 0x0, 0x0, 0x0, 0x0, 0x0
    .long 0x0, 0x0, 0x0, 0x0, 0x0, 0x0, 0x0, 0x0
    .long 0x0, 0x0, 0x0, 0x0, 0x0, 0x0, 0x0, 0x0
    .long 0x0, 0x0, 0x0, 0x0, 0x0, 0x0, 0x0, 0x3f800000
    .long 0x0, 0x0, 0x0, 0x3f80, 0x0, 0x0, 0x3f800000, 0x0
    .long 0x0, 0x0, 0x0, 0x0, 0x0, 0x0, 0x0, 0x0
    .long 0x0, 0x0, 0x0, 0x0, 0x0, 0x0, 0x0, 0x0
    .long 0x0, 0x0, 0x3f80, 0x0, 0x0, 0x3f800000, 0x0, 0x0
    .long 0x0, 0x3f80, 0x0, 0x0, 0x3f800000, 0x0, 0x0, 0x0
    .long 0x0, 0x0, 0x0, 0x0, 0x0, 0x0, 0x0, 0x0
    .long 0x0, 0x0, 0x0, 0x0, 0x0, 0x0, 0x0, 0x0
    .long 0x3f80, 0x0, 0x0, 0x0, 0x0, 0x0, 0x0, 0xbf800000
    .long 0x0, 0x0, 0x0, 0xbf80, 0x0, 0x0, 0xbf800000, 0x0
    .long 0x0, 0x0, 0x0, 0x0, 0x0, 0x0, 0x0, 0x0
    .long 0x0, 0x0, 0x0, 0x0, 0x0, 0x0, 0x0, 0x0
    .long 0x0, 0x0, 0xbf80, 0x0, 0x0, 0xbf800000, 0x0, 0x0
    .long 0x0, 0xbf80, 0x0, 0x0, 0xbf800000, 0x0, 0x0, 0x0
    .long 0x80008000, 0x80008000, 0x80008000, 0x80008000, 0x80008000, 0x80008000, 0x80008000, 0xbf808000
    .long 0x80008000, 0x80008000, 0x80008000, 0x8000bf80, 0x80008000, 0x80008000, 0xbf808000, 0x80008000
    .long 0x80008000, 0x80008000, 0x80008000, 0x80008000, 0x80008000, 0x80008000, 0x80008000, 0x80008000
    .long 0x80008000, 0x80008000, 0x80008000, 0x80008000, 0x80008000, 0x80008000, 0x80008000, 0x80008000
    .long 0x80008000, 0x80008000, 0x8000bf80, 0x80008000, 0x80008000, 0xbf808000, 0x80008000, 0x80008000
    .long 0x80008000, 0x8000bf80, 0x80008000, 0x80008000, 0xbf808000, 0x80008000, 0x80008000, 0x80008000
    .long 0x80008000, 0x80008000, 0x80008000, 0x80008000, 0x80008000, 0x80008000, 0x80008000, 0x80008000
    .long 0x80008000, 0x80008000, 0x80008000, 0x80008000, 0x80008000, 0x80008000, 0x80008000, 0x80008000
    .long 0x8000bf80, 0x80008000, 0x80008000, 0x80008000, 0x80008000, 0x80008000, 0x80008000, 0x3f808000
    .long 0x80008000, 0x80008000, 0x80008000, 0x80003f80, 0x80008000, 0x80008000, 0x3f808000, 0x80008000
    .long 0x80008000, 0x80008000, 0x80008000, 0x80008000, 0x80008000, 0x80008000, 0x80008000, 0x80008000
    .long 0x80008000, 0x80008000, 0x80008000, 0x80008000, 0x80008000, 0x80008000, 0x80008000, 0x80008000
    .long 0x80008000, 0x80008000, 0x80003f80, 0x80008000, 0x80008000, 0x3f808000, 0x80008000, 0x80008000
    .long 0x80008000, 0x80003f80, 0x80008000, 0x80008000, 0x3f808000, 0x80008000, 0x80008000, 0x80008000
    .long 0x80008000, 0x80008000, 0x80008000, 0x80008000, 0x80008000, 0x80008000, 0x80008000, 0x80008000
    .long 0x80008000, 0x80008000, 0x80008000, 0x80008000, 0x80008000, 0x80008000, 0x80008000, 0x80008000
    .long 0x80008000, 0x80008000, 0x80008000, 0x80008000, 0x80008000, 0x80008000, 0x80008000, 0x80008000
    .long 0x80008000, 0x80008000, 0x80008000, 0x80008000, 0x80008000, 0x80008000, 0x80008000, 0x80008000
    .long 0x80008000, 0x80008000, 0x80008000, 0x80008000, 0x80008000, 0x80008000, 0x80008000, 0xbf808000
    .long 0x80008000, 0x80008000, 0x80008000, 0x8000bf80, 0x80008000, 0x80008000, 0xbf808000, 0x80008000
    .long 0x80008000, 0x80008000, 0x80008000, 0x80008000, 0x80008000, 0x80008000, 0x80008000, 0x80008000
    .long 0x80008000, 0x80008000, 0x80008000, 0x80008000, 0x80008000, 0x80008000, 0x80008000, 0x80008000
    .long 0x80008000, 0x80008000, 0x8000bf80, 0x80008000, 0x80008000, 0xbf808000, 0x80008000, 0x80008000
    .long 0x80008000, 0x8000bf80, 0x80008000, 0x80008000, 0xbf808000, 0x80008000, 0x80008000, 0x80008000
    .long 0x80008000, 0x80008000, 0x80008000, 0x80008000, 0x80008000, 0x80008000, 0x80008000, 0x80008000
    .long 0x80008000, 0x80008000, 0x80008000, 0x80008000, 0x80008000, 0x80008000, 0x80008000, 0x80008000
    .long 0x8000bf80, 0x80008000, 0x80008000, 0x80008000, 0x80008000, 0x80008000, 0x80008000, 0x3f808000
    .long 0x80008000, 0x80008000, 0x80008000, 0x80003f80, 0x80008000, 0x80008000, 0x3f808000, 0x80008000
    .long 0x80008000, 0x80008000, 0x80008000, 0x80008000, 0x80008000, 0x80008000, 0x80008000, 0x80008000
    .long 0x80008000, 0x80008000, 0x80008000, 0x80008000, 0x80008000, 0x80008000, 0x80008000, 0x80008000
    .long 0x80008000, 0x80008000, 0x80003f80, 0x80008000, 0x80008000, 0x3f808000, 0x80008000, 0x80008000
    .long 0x80008000, 0x80003f80, 0x80008000, 0x80008000, 0x3f808000, 0x80008000, 0x80008000, 0x80008000
    .long 0x3f80, 0x8000bf80, 0x0, 0x80008000, 0x3f800000, 0xbf808000, 0x3f800000, 0xbf808000
    .long 0x0, 0x80008000, 0x3f80, 0x8000bf80, 0x3f800000, 0xbf808000, 0xbf800000, 0x3f808000
    .long 0x0, 0x80008000, 0x0, 0x80008000, 0x0, 0x80008000, 0x0, 0x80008000
    .long 0x0, 0x80008000, 0x0, 0x80008000, 0x0, 0x80008000, 0x0, 0x80008000
    .long 0x0, 0x80008000, 0x0, 0x80008000, 0x0, 0x80008000, 0x0, 0x80008000
    .long 0x0, 0x80008000, 0x0, 0x80008000, 0x0, 0x80008000, 0x0, 0x80008000
    .long 0x0, 0x80008000, 0x0, 0x80008000, 0x0, 0x80008000, 0x0, 0x80008000
    .long 0x0, 0x80008000, 0x0, 0x80008000, 0x0, 0x80008000, 0x0, 0x80008000
    .long 0x0, 0x80008000, 0x0, 0x80008000, 0x0, 0x80008000, 0x0, 0x80008000
    .long 0x0, 0x80008000, 0x0, 0x80008000, 0x0, 0x80008000, 0x0, 0x80008000
    .long 0x3f80, 0x8000bf80, 0x0, 0x80008000, 0x3f800000, 0xbf808000, 0x3f800000, 0xbf808000
    .long 0x0, 0x80008000, 0x3f80, 0x8000bf80, 0x3f800000, 0xbf808000, 0xbf800000, 0x3f808000
    .long 0x0, 0x80008000, 0x0, 0x80008000, 0x0, 0x80008000, 0x0, 0x80008000
    .long 0x0, 0x80008000, 0x0, 0x80008000, 0x0, 0x80008000, 0x0, 0x80008000
    .long 0x0, 0x80008000, 0x0, 0x80008000, 0x0, 0x80008000, 0x0, 0x80008000
    .long 0x0, 0x80008000, 0x0, 0x80008000, 0x0, 0x80008000, 0x0, 0x80008000
    .long 0x0, 0x80008000, 0x0, 0x80008000, 0x0, 0x80008000, 0x0, 0x80008000
    .long 0x0, 0x80008000, 0x0, 0x80008000, 0x0, 0x80008000, 0x0, 0x80008000
    .long 0x0, 0x80008000, 0x0, 0x80008000, 0x0, 0x80008000, 0x0, 0x80008000
    .long 0x0, 0x80008000, 0x0, 0x80008000, 0x0, 0x80008000, 0x0, 0x80008000
    .long 0x3f80, 0x8000bf80, 0x0, 0x80008000, 0x3f800000, 0xbf808000, 0x3f800000, 0xbf808000
    .long 0x0, 0x80008000, 0x3f80, 0x8000bf80, 0x3f800000, 0xbf808000, 0xbf800000, 0x3f808000
    .long 0x0, 0x80008000, 0x0, 0x80008000, 0x0, 0x80008000, 0x0, 0x80008000
    .long 0x0, 0x80008000, 0x0, 0x80008000, 0x0, 0x80008000, 0x0, 0x80008000
    .long 0x0, 0x80008000, 0x0, 0x80008000, 0x0, 0x80008000, 0x0, 0x80008000
    .long 0x0, 0x80008000, 0x0, 0x80008000, 0x0, 0x80008000, 0x0, 0x80008000
    .long 0x0, 0x80008000, 0x0, 0x80008000, 0x0, 0x80008000, 0x0, 0x80008000
    .long 0x0, 0x80008000, 0x0, 0x80008000, 0x0, 0x80008000, 0x0, 0x80008000
    .long 0x0, 0x80008000, 0x0, 0x80008000, 0x0, 0x80008000, 0x0, 0x80008000
    .long 0x0, 0x80008000, 0x0, 0x80008000, 0x0, 0x80008000, 0x0, 0x80008000
    .long 0x3f80, 0x8000bf80, 0x0, 0x80008000, 0x3f800000, 0xbf808000, 0x3f800000, 0xbf808000
    .long 0x0, 0x80008000, 0x3f80, 0x8000bf80, 0x3f800000, 0xbf808000, 0xbf800000, 0x3f808000
    .long 0x3f80, 0x0, 0x0, 0x0, 0x3f800000, 0x0, 0x0, 0x0
    .long 0x0, 0x3f80, 0x0, 0x0, 0x0, 0x3f800000, 0x0, 0x0
    .long 0x0, 0x0, 0x0, 0x0, 0x0, 0x0, 0x0, 0x0
    .long 0x0, 0x0, 0x0, 0x0, 0x0, 0x0, 0x0, 0x0
    .long 0x0, 0x0, 0x3f80, 0x0, 0x0, 0x0, 0x3f800000, 0x0
    .long 0x0, 0x0, 0x0, 0x3f80, 0x0, 0x0, 0x0, 0x3f800000
    .long 0x0, 0x0, 0x0, 0x0, 0x0, 0x0, 0x0, 0x0
    .long 0x0, 0x0, 0x0, 0x0, 0x0, 0x0, 0x0, 0x0
    .long 0x0, 0x0, 0x0, 0x0, 0x3f800000, 0x0, 0x0, 0x0
    .long 0x0, 0x3f80, 0x0, 0x0, 0x0, 0x3f800000, 0x0, 0x0
    .long 0x0, 0x0, 0x0, 0x0, 0x0, 0x0, 0x0, 0x0
    .long 0x0, 0x0, 0x0, 0x0, 0x0, 0x0, 0x0, 0x0
    .long 0x0, 0x0, 0x3f80, 0x0, 0x0, 0x0, 0x3f800000, 0x0
    .long 0x0, 0x0, 0x0, 0x3f80, 0x0, 0x0, 0x0, 0x3f800000
    .long 0x0, 0x0, 0x0, 0x0, 0x0, 0x0, 0x0, 0x0
    .long 0x0, 0x0, 0x0, 0x0, 0x0, 0x0, 0x0, 0x0
    .long 0x0, 0x0, 0x0, 0x0, 0x0, 0x0, 0x0, 0x0
    .long 0x0, 0x0, 0x0, 0x0, 0x0, 0x0, 0x0, 0x0
    .long 0x3f80, 0x0, 0x0, 0x0, 0x3f800000, 0x0, 0x0, 0x0
    .long 0x0, 0x3f80, 0x0, 0x0, 0x0, 0x3f800000, 0x0, 0x0
    .long 0x0, 0x0, 0x0, 0x0, 0x0, 0x0, 0x0, 0x0
    .long 0x0, 0x0, 0x0, 0x0, 0x0, 0x0, 0x0, 0x0
    .long 0x0, 0x0, 0x3f80, 0x0, 0x0, 0x0, 0x3f800000, 0x0
    .long 0x0, 0x0, 0x0, 0x3f80, 0x0, 0x0, 0x0, 0x3f800000
    .long 0x0, 0x0, 0x0, 0x0, 0x0, 0x0, 0x0, 0x0
    .long 0x0, 0x0, 0x0, 0x0, 0x0, 0x0, 0x0, 0x0
    .long 0x0, 0x0, 0x0, 0x0, 0x3f800000, 0x0, 0x0, 0x0
    .long 0x0, 0x3f80, 0x0, 0x0, 0x0, 0x3f800000, 0x0, 0x0
    .long 0x0, 0x0, 0x0, 0x0, 0x0, 0x0, 0x0, 0x0
    .long 0x0, 0x0, 0x0, 0x0, 0x0, 0x0, 0x0, 0x0
    .long 0x0, 0x0, 0x3f80, 0x0, 0x0, 0x0, 0x3f800000, 0x0
    .long 0x0, 0x0, 0x0, 0x3f80, 0x0, 0x0, 0x0, 0x3f800000
    .long 0x3f80, 0x0, 0x0, 0x0, 0x3f800000, 0x0, 0x0, 0x0
    .long 0x0, 0x3f80, 0x0, 0x0, 0x0, 0x3f800000, 0x0, 0x0
    .long 0x0, 0x0, 0x0, 0x0, 0x0, 0x0, 0x0, 0x0
    .long 0x0, 0x0, 0x0, 0x0, 0x0, 0x0, 0x0, 0x0
    .long 0x0, 0x0, 0x3f80, 0x0, 0x0, 0x0, 0x3f800000, 0x0
    .long 0x0, 0x0, 0x0, 0x3f80, 0x0, 0x0, 0x0, 0x3f800000
    .long 0x0, 0x0, 0x0, 0x0, 0x0, 0x0, 0x0, 0x0
    .long 0x0, 0x0, 0x0, 0x0, 0x0, 0x0, 0x0, 0x0
    .long 0x0, 0x0, 0x0, 0x0, 0x3f800000, 0x0, 0x0, 0x0
    .long 0x0, 0x3f80, 0x0, 0x0, 0x0, 0x3f800000, 0x0, 0x0
    .long 0x0, 0x0, 0x0, 0x0, 0x0, 0x0, 0x0, 0x0
    .long 0x0, 0x0, 0x0, 0x0, 0x0, 0x0, 0x0, 0x0
    .long 0x0, 0x0, 0x3f80, 0x0, 0x0, 0x0, 0x3f800000, 0x0
    .long 0x0, 0x0, 0x0, 0x3f80, 0x0, 0x0, 0x0, 0x3f800000
    .long 0x0, 0x0, 0x0, 0x0, 0x0, 0x0, 0x0, 0x0
    .long 0x0, 0x0, 0x0, 0x0, 0x0, 0x0, 0x0, 0x0
    .long 0x0, 0x0, 0x0, 0x0, 0x0, 0x0, 0x0, 0x0
    .long 0x0, 0x0, 0x0, 0x0, 0x0, 0x0, 0x0, 0x0
    .long 0x3f80, 0x0, 0x0, 0x0, 0x3f800000, 0x0, 0x0, 0x0
    .long 0x0, 0x3f80, 0x0, 0x0, 0x0, 0x3f800000, 0x0, 0x0
    .long 0x0, 0x0, 0x0, 0x0, 0x0, 0x0, 0x0, 0x0
    .long 0x0, 0x0, 0x0, 0x0, 0x0, 0x0, 0x0, 0x0
    .long 0x0, 0x0, 0x3f80, 0x0, 0x0, 0x0, 0x3f800000, 0x0
    .long 0x0, 0x0, 0x0, 0x3f80, 0x0, 0x0, 0x0, 0x3f800000
    .long 0x0, 0x0, 0x0, 0x0, 0x0, 0x0, 0x0, 0x0
    .long 0x0, 0x0, 0x0, 0x0, 0x0, 0x0, 0x0, 0x0
    .long 0x0, 0x0, 0x0, 0x0, 0x3f800000, 0x0, 0x0, 0x0
    .long 0x0, 0x3f80, 0x0, 0x0, 0x0, 0x3f800000, 0x0, 0x0
    .long 0x0, 0x0, 0x0, 0x0, 0x0, 0x0, 0x0, 0x0
    .long 0x0, 0x0, 0x0, 0x0, 0x0, 0x0, 0x0, 0x0
    .long 0x0, 0x0, 0x3f80, 0x0, 0x0, 0x0, 0x3f800000, 0x0
    .long 0x0, 0x0, 0x0, 0x3f80, 0x0, 0x0, 0x0, 0x3f800000
    .long 0x0, 0x0, 0x0, 0x0, 0x0, 0x0, 0x0, 0x3f800000
    .long 0x0, 0x0, 0x0, 0x3f80, 0x0, 0x0, 0x3f800000, 0x0
    .long 0x0, 0x0, 0x0, 0x0, 0x0, 0x0, 0x0, 0x0
    .long 0x0, 0x0, 0x0, 0x0, 0x0, 0x0, 0x0, 0x0
    .long 0x0, 0x0, 0x3f80, 0x0, 0x0, 0x3f800000, 0x0, 0x0
    .long 0x0, 0x3f80, 0x0, 0x0, 0x3f800000, 0x0, 0x0, 0x0
    .long 0x0, 0x0, 0x0, 0x0, 0x0, 0x0, 0x0, 0x0
    .long 0x0, 0x0, 0x0, 0x0, 0x0, 0x0, 0x0, 0x0
    .long 0x3f80, 0x0, 0x0, 0x0, 0x0, 0x0, 0x0, 0xbf800000
    .long 0x0, 0x0, 0x0, 0xbf80, 0x0, 0x0, 0xbf800000, 0x0
    .long 0x0, 0x0, 0x0, 0x0, 0x0, 0x0, 0x0, 0x0
    .long 0x0, 0x0, 0x0, 0x0, 0x0, 0x0, 0x0, 0x0
    .long 0x0, 0x0, 0xbf80, 0x0, 0x0, 0xbf800000, 0x0, 0x0
    .long 0x0, 0xbf80, 0x0, 0x0, 0xbf800000, 0x0, 0x0, 0x0
    .long 0x0, 0x0, 0x0, 0x0, 0x0, 0x0, 0x0, 0x0
    .long 0x0, 0x0, 0x0, 0x0, 0x0, 0x0, 0x0, 0x0
    .long 0x0, 0x0, 0x0, 0x0, 0x0, 0x0, 0x0, 0x0
    .long 0x0, 0x0, 0x0, 0x0, 0x0, 0x0, 0x0, 0x0
    .long 0x0, 0x0, 0x0, 0x0, 0x0, 0x0, 0x0, 0x3f800000
    .long 0x0, 0x0, 0x0, 0x3f80, 0x0, 0x0, 0x3f800000, 0x0
    .long 0x0, 0x0, 0x0, 0x0, 0x0, 0x0, 0x0, 0x0
    .long 0x0, 0x0, 0x0, 0x0, 0x0, 0x0, 0x0, 0x0
    .long 0x0, 0x0, 0x3f80, 0x0, 0x0, 0x3f800000, 0x0, 0x0
    .long 0x0, 0x3f80, 0x0, 0x0, 0x3f800000, 0x0, 0x0, 0x0
    .long 0x0, 0x0, 0x0, 0x0, 0x0, 0x0, 0x0, 0x0
    .long 0x0, 0x0, 0x0, 0x0, 0x0, 0x0, 0x0, 0x0
    .long 0x3f80, 0x0, 0x0, 0x0, 0x0, 0x0, 0x0, 0xbf800000
    .long 0x0, 0x0, 0x0, 0xbf80, 0x0, 0x0, 0xbf800000, 0x0
    .long 0x0, 0x0, 0x0, 0x0, 0x0, 0x0, 0x0, 0x0
    .long 0x0, 0x0, 0x0, 0x0, 0x0, 0x0, 0x0, 0x0
    .long 0x0, 0x0, 0xbf80, 0x0, 0x0, 0xbf800000, 0x0, 0x0
    .long 0x0, 0xbf80, 0x0, 0x0, 0xbf800000, 0x0, 0x0, 0x0
    .long 0x0, 0x0, 0x0, 0x0, 0x0, 0x0, 0x0, 0x3f800000
    .long 0x0, 0x0, 0x0, 0x3f80, 0x0, 0x0, 0x3f800000, 0x0
    .long 0x0, 0x0, 0x0, 0x0, 0x0, 0x0, 0x0, 0x0
    .long 0x0, 0x0, 0x0, 0x0, 0x0, 0x0, 0x0, 0x0
    .long 0x0, 0x0, 0x3f80, 0x0, 0x0, 0x3f800000, 0x0, 0x0
    .long 0x0, 0x3f80, 0x0, 0x0, 0x3f800000, 0x0, 0x0, 0x0
    .long 0x0, 0x0, 0x0, 0x0, 0x0, 0x0, 0x0, 0x0
    .long 0x0, 0x0, 0x0, 0x0, 0x0, 0x0, 0x0, 0x0
    .long 0x3f80, 0x0, 0x0, 0x0, 0x0, 0x0, 0x0, 0xbf800000
    .long 0x0, 0x0, 0x0, 0xbf80, 0x0, 0x0, 0xbf800000, 0x0
    .long 0x0, 0x0, 0x0, 0x0, 0x0, 0x0, 0x0, 0x0
    .long 0x0, 0x0, 0x0, 0x0, 0x0, 0x0, 0x0, 0x0
    .long 0x0, 0x0, 0xbf80, 0x0, 0x0, 0xbf800000, 0x0, 0x0
    .long 0x0, 0xbf80, 0x0, 0x0, 0xbf800000, 0x0, 0x0, 0x0
    .long 0x0, 0x0, 0x0, 0x0, 0x0, 0x0, 0x0, 0x0
    .long 0x0, 0x0, 0x0, 0x0, 0x0, 0x0, 0x0, 0x0
    .long 0x0, 0x0, 0x0, 0x0, 0x0, 0x0, 0x0, 0x0
    .long 0x0, 0x0, 0x0, 0x0, 0x0, 0x0, 0x0, 0x0
    .long 0x0, 0x0, 0x0, 0x0, 0x0, 0x0, 0x0, 0x3f800000
    .long 0x0, 0x0, 0x0, 0x3f80, 0x0, 0x0, 0x3f800000, 0x0
    .long 0x0, 0x0, 0x0, 0x0, 0x0, 0x0, 0x0, 0x0
    .long 0x0, 0x0, 0x0, 0x0, 0x0, 0x0, 0x0, 0x0
    .long 0x0, 0x0, 0x3f80, 0x0, 0x0, 0x3f800000, 0x0, 0x0
    .long 0x0, 0x3f80, 0x0, 0x0, 0x3f800000, 0x0, 0x0, 0x0
    .long 0x0, 0x0, 0x0, 0x0, 0x0, 0x0, 0x0, 0x0
    .long 0x0, 0x0, 0x0, 0x0, 0x0, 0x0, 0x0, 0x0
    .long 0x3f80, 0x0, 0x0, 0x0, 0x0, 0x0, 0x0, 0xbf800000
    .long 0x0, 0x0, 0x0, 0xbf80, 0x0, 0x0, 0xbf800000, 0x0
    .long 0x0, 0x0, 0x0, 0x0, 0x0, 0x0, 0x0, 0x0
    .long 0x0, 0x0, 0x0, 0x0, 0x0, 0x0, 0x0, 0x0
    .long 0x0, 0x0, 0xbf80, 0x0, 0x0, 0xbf800000, 0x0, 0x0
    .long 0x0, 0xbf80, 0x0, 0x0, 0xbf800000, 0x0, 0x0, 0x0
    .long 0x3f80, 0x3f80, 0x0, 0x0, 0x3f800000, 0x3f800000, 0x3f800000, 0x3f800000
    .long 0x0, 0x0, 0x3f80, 0x3f80, 0x3f800000, 0x3f800000, 0xbf800000, 0xbf800000
    .long 0x0, 0x0, 0x0, 0x0, 0x0, 0x0, 0x0, 0x0
    .long 0x0, 0x0, 0x0, 0x0, 0x0, 0x0, 0x0, 0x0
    .long 0x0, 0x0, 0x0, 0x0, 0x0, 0x0, 0x0, 0x0
    .long 0x0, 0x0, 0x0, 0x0, 0x0, 0x0, 0x0, 0x0
    .long 0x0, 0x0, 0x0, 0x0, 0x0, 0x0, 0x0, 0x0
    .long 0x0, 0x0, 0x0, 0x0, 0x0, 0x0, 0x0, 0x0
    .long 0x0, 0x0, 0x0, 0x0, 0x0, 0x0, 0x0, 0x0
    .long 0x0, 0x0, 0x0, 0x0, 0x0, 0x0, 0x0, 0x0
    .long 0x3f80, 0x3f80, 0x0, 0x0, 0x3f800000, 0x3f800000, 0x3f800000, 0x3f800000
    .long 0x0, 0x0, 0x3f80, 0x3f80, 0x3f800000, 0x3f800000, 0xbf800000, 0xbf800000
    .long 0x0, 0x0, 0x0, 0x0, 0x0, 0x0, 0x0, 0x0
    .long 0x0, 0x0, 0x0, 0x0, 0x0, 0x0, 0x0, 0x0
    .long 0x0, 0x0, 0x0, 0x0, 0x0, 0x0, 0x0, 0x0
    .long 0x0, 0x0, 0x0, 0x0, 0x0, 0x0, 0x0, 0x0
    .long 0x0, 0x0, 0x0, 0x0, 0x0, 0x0, 0x0, 0x0
    .long 0x0, 0x0, 0x0, 0x0, 0x0, 0x0, 0x0, 0x0
    .long 0x0, 0x0, 0x0, 0x0, 0x0, 0x0, 0x0, 0x0
    .long 0x0, 0x0, 0x0, 0x0, 0x0, 0x0, 0x0, 0x0
    .long 0x3f80, 0x3f80, 0x0, 0x0, 0x3f800000, 0x3f800000, 0x3f800000, 0x3f800000
    .long 0x0, 0x0, 0x3f80, 0x3f80, 0x3f800000, 0x3f800000, 0xbf800000, 0xbf800000
    .long 0x0, 0x0, 0x0, 0x0, 0x0, 0x0, 0x0, 0x0
    .long 0x0, 0x0, 0x0, 0x0, 0x0, 0x0, 0x0, 0x0
    .long 0x0, 0x0, 0x0, 0x0, 0x0, 0x0, 0x0, 0x0
    .long 0x0, 0x0, 0x0, 0x0, 0x0, 0x0, 0x0, 0x0
    .long 0x0, 0x0, 0x0, 0x0, 0x0, 0x0, 0x0, 0x0
    .long 0x0, 0x0, 0x0, 0x0, 0x0, 0x0, 0x0, 0x0
    .long 0x0, 0x0, 0x0, 0x0, 0x0, 0x0, 0x0, 0x0
    .long 0x0, 0x0, 0x0, 0x0, 0x0, 0x0, 0x0, 0x0
    .long 0x3f80, 0x3f80, 0x0, 0x0, 0x3f800000, 0x3f800000, 0x3f800000, 0x3f800000
    .long 0x0, 0x0, 0x3f80, 0x3f80, 0x3f800000, 0x3f800000, 0xbf800000, 0xbf800000
    .long 0x8000bf80, 0x80008000, 0x80008000, 0x80008000, 0xbf808000, 0x80008000, 0x80008000, 0x80008000
    .long 0x80008000, 0x8000bf80, 0x80008000, 0x80008000, 0x80008000, 0xbf808000, 0x80008000, 0x80008000
    .long 0x80008000, 0x80008000, 0x80008000, 0x80008000, 0x80008000, 0x80008000, 0x80008000, 0x80008000
    .long 0x80008000, 0x80008000, 0x80008000, 0x80008000, 0x80008000, 0x80008000, 0x80008000, 0x80008000
    .long 0x80008000, 0x80008000, 0x8000bf80, 0x80008000, 0x80008000, 0x80008000, 0xbf808000, 0x80008000
    .long 0x80008000, 0x80008000, 0x80008000, 0x8000bf80, 0x80008000, 0x80008000, 0x80008000, 0xbf808000
    .long 0x80008000, 0x80008000, 0x80008000, 0x80008000, 0x80008000, 0x80008000, 0x80008000, 0x80008000
    .long 0x80008000, 0x80008000, 0x80008000, 0x80008000, 0x80008000, 0x80008000, 0x80008000, 0x80008000
    .long 0x80008000, 0x80008000, 0x80008000, 0x80008000, 0xbf808000, 0x80008000, 0x80008000, 0x80008000
    .long 0x80008000, 0x8000bf80, 0x80008000, 0x80008000, 0x80008000, 0xbf808000, 0x80008000, 0x80008000
    .long 0x80008000, 0x80008000, 0x80008000, 0x80008000, 0x80008000, 0x80008000, 0x80008000, 0x80008000
    .long 0x80008000, 0x80008000, 0x80008000, 0x80008000, 0x80008000, 0x80008000, 0x80008000, 0x80008000
    .long 0x80008000, 0x80008000, 0x8000bf80, 0x80008000, 0x80008000, 0x80008000, 0xbf808000, 0x80008000
    .long 0x80008000, 0x80008000, 0x80008000, 0x8000bf80, 0x80008000, 0x80008000, 0x80008000, 0xbf808000
    .long 0x80008000, 0x80008000, 0x80008000, 0x80008000, 0x80008000, 0x80008000, 0x80008000, 0x80008000
    .long 0x80008000, 0x80008000, 0x80008000, 0x80008000, 0x80008000, 0x80008000, 0x80008000, 0x80008000
    .long 0x80008000, 0x80008000, 0x80008000, 0x80008000, 0x80008000, 0x80008000, 0x80008000, 0x80008000
    .long 0x80008000, 0x80008000, 0x80008000, 0x80008000, 0x80008000, 0x80008000, 0x80008000, 0x80008000
    .long 0x8000bf80, 0x80008000, 0x80008000, 0x80008000, 0xbf808000, 0x80008000, 0x80008000, 0x80008000
    .long 0x80008000, 0x8000bf80, 0x80008000, 0x80008000, 0x80008000, 0xbf808000, 0x80008000, 0x80008000
    .long 0x80008000, 0x80008000, 0x80008000, 0x80008000, 0x80008000, 0x80008000, 0x80008000, 0x80008000
    .long 0x80008000, 0x80008000, 0x80008000, 0x80008000, 0x80008000, 0x80008000, 0x80008000, 0x80008000
    .long 0x80008000, 0x80008000, 0x8000bf80, 0x80008000, 0x80008000, 0x80008000, 0xbf808000, 0x80008000
    .long 0x80008000, 0x80008000, 0x80008000, 0x8000bf80, 0x80008000, 0x80008000, 0x80008000, 0xbf808000
    .long 0x80008000, 0x80008000, 0x80008000, 0x80008000, 0x80008000, 0x80008000, 0x80008000, 0x80008000
    .long 0x80008000, 0x80008000, 0x80008000, 0x80008000, 0x80008000, 0x80008000, 0x80008000, 0x80008000
    .long 0x80008000, 0x80008000, 0x80008000, 0x80008000, 0xbf808000, 0x80008000, 0x80008000, 0x80008000
    .long 0x80008000, 0x8000bf80, 0x80008000, 0x80008000, 0x80008000, 0xbf808000, 0x80008000, 0x80008000
    .long 0x80008000, 0x80008000, 0x80008000, 0x80008000, 0x80008000, 0x80008000, 0x80008000, 0x80008000
    .long 0x80008000, 0x80008000, 0x80008000, 0x80008000, 0x80008000, 0x80008000, 0x80008000, 0x80008000
    .long 0x80008000, 0x80008000, 0x8000bf80, 0x80008000, 0x80008000, 0x80008000, 0xbf808000, 0x80008000
    .long 0x80008000, 0x80008000, 0x80008000, 0x8000bf80, 0x80008000, 0x80008000, 0x80008000, 0xbf808000
    .long 0x3f80, 0x0, 0x0, 0x0, 0x3f800000, 0x0, 0x0, 0x0
    .long 0x0, 0x3f80, 0x0, 0x0, 0x0, 0x3f800000, 0x0, 0x0
    .long 0x0, 0x0, 0x0, 0x0, 0x0, 0x0, 0x0, 0x0
    .long 0x0, 0x0, 0x0, 0x0, 0x0, 0x0, 0x0, 0x0
    .long 0x0, 0x0, 0x3f80, 0x0, 0x0, 0x0, 0x3f800000, 0x0
    .long 0x0, 0x0, 0x0, 0x3f80, 0x0, 0x0, 0x0, 0x3f800000
    .long 0x0, 0x0, 0x0, 0x0, 0x0, 0x0, 0x0, 0x0
    .long 0x0, 0x0, 0x0, 0x0, 0x0, 0x0, 0x0, 0x0
    .long 0x0, 0x0, 0x0, 0x0, 0x3f800000, 0x0, 0x0, 0x0
    .long 0x0, 0x3f80, 0x0, 0x0, 0x0, 0x3f800000, 0x0, 0x0
    .long 0x0, 0x0, 0x0, 0x0, 0x0, 0x0, 0x0, 0x0
    .long 0x0, 0x0, 0x0, 0x0, 0x0, 0x0, 0x0, 0x0
    .long 0x0, 0x0, 0x3f80, 0x0, 0x0, 0x0, 0x3f800000, 0x0
    .long 0x0, 0x0, 0x0, 0x3f80, 0x0, 0x0, 0x0, 0x3f800000
    .long 0x0, 0x0, 0x0, 0x0, 0x0, 0x0, 0x0, 0x0
    .long 0x0, 0x0, 0x0, 0x0, 0x0, 0x0, 0x0, 0x0
    .long 0x0, 0x0, 0x0, 0x0, 0x0, 0x0, 0x0, 0x0
    .long 0x0, 0x0, 0x0, 0x0, 0x0, 0x0, 0x0, 0x0
    .long 0x3f80, 0x0, 0x0, 0x0, 0x3f800000, 0x0, 0x0, 0x0
    .long 0x0, 0x3f80, 0x0, 0x0, 0x0, 0x3f800000, 0x0, 0x0
    .long 0x0, 0x0, 0x0, 0x0, 0x0, 0x0, 0x0, 0x0
    .long 0x0, 0x0, 0x0, 0x0, 0x0, 0x0, 0x0, 0x0
    .long 0x0, 0x0, 0x3f80, 0x0, 0x0, 0x0, 0x3f800000, 0x0
    .long 0x0, 0x0, 0x0, 0x3f80, 0x0, 0x0, 0x0, 0x3f800000
    .long 0x0, 0x0, 0x0, 0x0, 0x0, 0x0, 0x0, 0x0
    .long 0x0, 0x0, 0x0, 0x0, 0x0, 0x0, 0x0, 0x0
    .long 0x0, 0x0, 0x0, 0x0, 0x3f800000, 0x0, 0x0, 0x0
    .long 0x0, 0x3f80, 0x0, 0x0, 0x0, 0x3f800000, 0x0, 0x0
    .long 0x0, 0x0, 0x0, 0x0, 0x0, 0x0, 0x0, 0x0
    .long 0x0, 0x0, 0x0, 0x0, 0x0, 0x0, 0x0, 0x0
    .long 0x0, 0x0, 0x3f80, 0x0, 0x0, 0x0, 0x3f800000, 0x0
    .long 0x0, 0x0, 0x0, 0x3f80, 0x0, 0x0, 0x0, 0x3f800000
    .long 0x80008000, 0x80008000, 0x80008000, 0x80008000, 0x80008000, 0x80008000, 0x80008000, 0xbf808000
    .long 0x80008000, 0x80008000, 0x80008000, 0x8000bf80, 0x80008000, 0x80008000, 0xbf808000, 0x80008000
    .long 0x80008000, 0x80008000, 0x80008000, 0x80008000, 0x80008000, 0x80008000, 0x80008000, 0x80008000
    .long 0x80008000, 0x80008000, 0x80008000, 0x80008000, 0x80008000, 0x80008000, 0x80008000, 0x80008000
    .long 0x80008000, 0x80008000, 0x8000bf80, 0x80008000, 0x80008000, 0xbf808000, 0x80008000, 0x80008000
    .long 0x80008000, 0x8000bf80, 0x80008000, 0x80008000, 0xbf808000, 0x80008000, 0x80008000, 0x80008000
    .long 0x80008000, 0x80008000, 0x80008000, 0x80008000, 0x80008000, 0x80008000, 0x80008000, 0x80008000
    .long 0x80008000, 0x80008000, 0x80008000, 0x80008000, 0x80008000, 0x80008000, 0x80008000, 0x80008000
    .long 0x8000bf80, 0x80008000, 0x80008000, 0x80008000, 0x80008000, 0x80008000, 0x80008000, 0x3f808000
    .long 0x80008000, 0x80008000, 0x80008000, 0x80003f80, 0x80008000, 0x80008000, 0x3f808000, 0x80008000
    .long 0x80008000, 0x80008000, 0x80008000, 0x80008000, 0x80008000, 0x80008000, 0x80008000, 0x80008000
    .long 0x80008000, 0x80008000, 0x80008000, 0x80008000, 0x80008000, 0x80008000, 0x80008000, 0x80008000
    .long 0x80008000, 0x80008000, 0x80003f80, 0x80008000, 0x80008000, 0x3f808000, 0x80008000, 0x80008000
    .long 0x80008000, 0x80003f80, 0x80008000, 0x80008000, 0x3f808000, 0x80008000, 0x80008000, 0x80008000
    .long 0x80008000, 0x80008000, 0x80008000, 0x80008000, 0x80008000, 0x80008000, 0x80008000, 0x80008000
    .long 0x80008000, 0x80008000, 0x80008000, 0x80008000, 0x80008000, 0x80008000, 0x80008000, 0x80008000
    .long 0x80008000, 0x80008000, 0x80008000, 0x80008000, 0x80008000, 0x80008000, 0x80008000, 0x80008000
    .long 0x80008000, 0x80008000, 0x80008000, 0x80008000, 0x80008000, 0x80008000, 0x80008000, 0x80008000
    .long 0x80008000, 0x80008000, 0x80008000, 0x80008000, 0x80008000, 0x80008000, 0x80008000, 0xbf808000
    .long 0x80008000, 0x80008000, 0x80008000, 0x8000bf80, 0x80008000, 0x80008000, 0xbf808000, 0x80008000
    .long 0x80008000, 0x80008000, 0x80008000, 0x80008000, 0x80008000, 0x80008000, 0x80008000, 0x80008000
    .long 0x80008000, 0x80008000, 0x80008000, 0x80008000, 0x80008000, 0x80008000, 0x80008000, 0x80008000
    .long 0x80008000, 0x80008000, 0x8000bf80, 0x80008000, 0x80008000, 0xbf808000, 0x80008000, 0x80008000
    .long 0x80008000, 0x8000bf80, 0x80008000, 0x80008000, 0xbf808000, 0x80008000, 0x80008000, 0x80008000
    .long 0x80008000, 0x80008000, 0x80008000, 0x80008000, 0x80008000, 0x80008000, 0x80008000, 0x80008000
    .long 0x80008000, 0x80008000, 0x80008000, 0x80008000, 0x80008000, 0x80008000, 0x80008000, 0x80008000
    .long 0x8000bf80, 0x80008000, 0x80008000, 0x80008000, 0x80008000, 0x80008000, 0x80008000, 0x3f808000
    .long 0x80008000, 0x80008000, 0x80008000, 0x80003f80, 0x80008000, 0x80008000, 0x3f808000, 0x80008000
    .long 0x80008000, 0x80008000, 0x80008000, 0x80008000, 0x80008000, 0x80008000, 0x80008000, 0x80008000
    .long 0x80008000, 0x80008000, 0x80008000, 0x80008000, 0x80008000, 0x80008000, 0x80008000, 0x80008000
    .long 0x80008000, 0x80008000, 0x80003f80, 0x80008000, 0x80008000, 0x3f808000, 0x80008000, 0x80008000
    .long 0x80008000, 0x80003f80, 0x80008000, 0x80008000, 0x3f808000, 0x80008000, 0x80008000, 0x80008000
    .long 0x0, 0x0, 0x0, 0x0, 0x0, 0x0, 0x0, 0x3f800000
    .long 0x0, 0x0, 0x0, 0x3f80, 0x0, 0x0, 0x3f800000, 0x0
    .long 0x0, 0x0, 0x0, 0x0, 0x0, 0x0, 0x0, 0x0
    .long 0x0, 0x0, 0x0, 0x0, 0x0, 0x0, 0x0, 0x0
    .long 0x0, 0x0, 0x3f80, 0x0, 0x0, 0x3f800000, 0x0, 0x0
    .long 0x0, 0x3f80, 0x0, 0x0, 0x3f800000, 0x0, 0x0, 0x0
    .long 0x0, 0x0, 0x0, 0x0, 0x0, 0x0, 0x0, 0x0
    .long 0x0, 0x0, 0x0, 0x0, 0x0, 0x0, 0x0, 0x0
    .long 0x3f80, 0x0, 0x0, 0x0, 0x0, 0x0, 0x0, 0xbf800000
    .long 0x0, 0x0, 0x0, 0xbf80, 0x0, 0x0, 0xbf800000, 0x0
    .long 0x0, 0x0, 0x0, 0x0, 0x0, 0x0, 0x0, 0x0
    .long 0x0, 0x0, 0x0, 0x0, 0x0, 0x0, 0x0, 0x0
    .long 0x0, 0x0, 0xbf80, 0x0, 0x0, 0xbf800000, 0x0, 0x0
    .long 0x0, 0xbf80, 0x0, 0x0, 0xbf800000, 0x0, 0x0, 0x0
    .long 0x0, 0x0, 0x0, 0x0, 0x0, 0x0, 0x0, 0x0
    .long 0x0, 0x0, 0x0, 0x0, 0x0, 0x0, 0x0, 0x0
    .long 0x0, 0x0, 0x0, 0x0, 0x0, 0x0, 0x0, 0x0
    .long 0x0, 0x0, 0x0, 0x0, 0x0, 0x0, 0x0, 0x0
    .long 0x0, 0x0, 0x0, 0x0, 0x0, 0x0, 0x0, 0x3f800000
    .long 0x0, 0x0, 0x0, 0x3f80, 0x0, 0x0, 0x3f800000, 0x0
    .long 0x0, 0x0, 0x0, 0x0, 0x0, 0x0, 0x0, 0x0
    .long 0x0, 0x0, 0x0, 0x0, 0x0, 0x0, 0x0, 0x0
    .long 0x0, 0x0, 0x3f80, 0x0, 0x0, 0x3f800000, 0x0, 0x0
    .long 0x0, 0x3f80, 0x0, 0x0, 0x3f800000, 0x0, 0x0, 0x0
    .long 0x0, 0x0, 0x0, 0x0, 0x0, 0x0, 0x0, 0x0
    .long 0x0, 0x0, 0x0, 0x0, 0x0, 0x0, 0x0, 0x0
    .long 0x3f80, 0x0, 0x0, 0x0, 0x0, 0x0, 0x0, 0xbf800000
    .long 0x0, 0x0, 0x0, 0xbf80, 0x0, 0x0, 0xbf800000, 0x0
    .long 0x0, 0x0, 0x0, 0x0, 0x0, 0x0, 0x0, 0x0
    .long 0x0, 0x0, 0x0, 0x0, 0x0, 0x0, 0x0, 0x0
    .long 0x0, 0x0, 0xbf80, 0x0, 0x0, 0xbf800000, 0x0, 0x0
    .long 0x0, 0xbf80, 0x0, 0x0, 0xbf800000, 0x0, 0x0, 0x0
    .long 0x8000bf80, 0x3f80, 0x80008000, 0x0, 0xbf808000, 0x3f800000, 0xbf808000, 0x3f800000
    .long 0x80008000, 0x0, 0x8000bf80, 0x3f80, 0xbf808000, 0x3f800000, 0x3f808000, 0xbf800000
    .long 0x80008000, 0x0, 0x80008000, 0x0, 0x80008000, 0x0, 0x80008000, 0x0
    .long 0x80008000, 0x0, 0x80008000, 0x0, 0x80008000, 0x0, 0x80008000, 0x0
    .long 0x80008000, 0x0, 0x80008000, 0x0, 0x80008000, 0x0, 0x80008000, 0x0
    .long 0x80008000, 0x0, 0x80008000, 0x0, 0x80008000, 0x0, 0x80008000, 0x0
    .long 0x80008000, 0x0, 0x80008000, 0x0, 0x80008000, 0x0, 0x80008000, 0x0
    .long 0x80008000, 0x0, 0x80008000, 0x0, 0x80008000, 0x0, 0x80008000, 0x0
    .long 0x80008000, 0x0, 0x80008000, 0x0, 0x80008000, 0x0, 0x80008000, 0x0
    .long 0x80008000, 0x0, 0x80008000, 0x0, 0x80008000, 0x0, 0x80008000, 0x0
    .long 0x8000bf80, 0x3f80, 0x80008000, 0x0, 0xbf808000, 0x3f800000, 0xbf808000, 0x3f800000
    .long 0x80008000, 0x0, 0x8000bf80, 0x3f80, 0xbf808000, 0x3f800000, 0x3f808000, 0xbf800000
    .long 0x80008000, 0x0, 0x80008000, 0x0, 0x80008000, 0x0, 0x80008000, 0x0
    .long 0x80008000, 0x0, 0x80008000, 0x0, 0x80008000, 0x0, 0x80008000, 0x0
    .long 0x80008000, 0x0, 0x80008000, 0x0, 0x80008000, 0x0, 0x80008000, 0x0
    .long 0x80008000, 0x0, 0x80008000, 0x0, 0x80008000, 0x0, 0x80008000, 0x0
    .long 0x80008000, 0x0, 0x80008000, 0x0, 0x80008000, 0x0, 0x80008000, 0x0
    .long 0x80008000, 0x0, 0x80008000, 0x0, 0x80008000, 0x0, 0x80008000, 0x0
    .long 0x80008000, 0x0, 0x80008000, 0x0, 0x80008000, 0x0, 0x80008000, 0x0
    .long 0x80008000, 0x0, 0x80008000, 0x0, 0x80008000, 0x0, 0x80008000, 0x0
    .long 0x8000bf80, 0x3f80, 0x80008000, 0x0, 0xbf808000, 0x3f800000, 0xbf808000, 0x3f800000
    .long 0x80008000, 0x0, 0x8000bf80, 0x3f80, 0xbf808000, 0x3f800000, 0x3f808000, 0xbf800000
    .long 0x80008000, 0x0, 0x80008000, 0x0, 0x80008000, 0x0, 0x80008000, 0x0
    .long 0x80008000, 0x0, 0x80008000, 0x0, 0x80008000, 0x0, 0x80008000, 0x0
    .long 0x80008000, 0x0, 0x80008000, 0x0, 0x80008000, 0x0, 0x80008000, 0x0
    .long 0x80008000, 0x0, 0x80008000, 0x0, 0x80008000, 0x0, 0x80008000, 0x0
    .long 0x80008000, 0x0, 0x80008000, 0x0, 0x80008000, 0x0, 0x80008000, 0x0
    .long 0x80008000, 0x0, 0x80008000, 0x0, 0x80008000, 0x0, 0x80008000, 0x0
    .long 0x80008000, 0x0, 0x80008000, 0x0, 0x80008000, 0x0, 0x80008000, 0x0
    .long 0x80008000, 0x0, 0x80008000, 0x0, 0x80008000, 0x0, 0x80008000, 0x0
    .long 0x8000bf80, 0x3f80, 0x80008000, 0x0, 0xbf808000, 0x3f800000, 0xbf808000, 0x3f800000
    .long 0x80008000, 0x0, 0x8000bf80, 0x3f80, 0xbf808000, 0x3f800000, 0x3f808000, 0xbf800000

.section .rodata,"a"
.p2align 6
.amdhsa_kernel recurrent_scan__spectral_fnet__moe_arch_mod__prompt_kernel
  .amdhsa_next_free_vgpr 128
  .amdhsa_next_free_sgpr 100
  .amdhsa_accum_offset 128
  .amdhsa_group_segment_fixed_size 0
  .amdhsa_kernarg_size 104
  .amdhsa_user_sgpr_count 2
  .amdhsa_user_sgpr_kernarg_segment_ptr 1
  .amdhsa_system_sgpr_workgroup_id_x 1
  .amdhsa_float_denorm_mode_32 3
  .amdhsa_float_denorm_mode_16_64 3
.end_amdhsa_kernel
```
